```python
import torch

def _softmax(x, axis=-1):
    return torch.softmax(x, dim=axis)
def _gelu(x):
    return torch.nn.functional.gelu(x, approximate="tanh")
def _silu(x):
    return torch.nn.functional.silu(x)
def _sigmoid(x):
    return torch.sigmoid(x)
def _layernorm(x, axis=-1, eps=1e-5):
    m = x.mean(dim=axis, keepdim=True)
    v = x.var(dim=axis, keepdim=True, unbiased=False)
    return (x - m) / torch.sqrt(v + eps)
def _scatter_add(tgt, idx, src, axis=0):
    return tgt.clone().index_add_(axis, idx, src)
def _segment_sum(src, seg, n):
    out = torch.zeros((n,) + src.shape[1:], dtype=src.dtype)
    return out.index_add_(0, seg, src)
def _pad(x, pw):
    flat = tuple(v for pair in reversed(pw) for v in pair)
    return torch.nn.functional.pad(x, flat)

kernel_name = 'interleave_layers__gqa_block_cached__gqa_block_cached__decode'

def setup_inputs():

    _w = (lambda a: (lambda t: t.to(torch.bfloat16) if t.is_floating_point() else t)(torch.as_tensor(a)))
    def _A_setup():
        B, Sq, D = 8, 1, 448
        Hq, Hkv, Sk, Dh = 16, 8, 4096, 256
        assert Hq % Hkv == 0, (Hq, Hkv)
        return {
            "x": _w((lambda *s: torch.randn(*s, dtype=torch.bfloat16) * 0.1)(B, Sq, D)),
            "k_cache": _w((lambda *s: torch.randn(*s, dtype=torch.bfloat16) * 0.8)(B, Hkv, Sk, Dh)),
            "v_cache": _w((lambda *s: torch.randn(*s, dtype=torch.bfloat16) * 3.2)(B, Hkv, Sk, Dh)),
            "wq": _w((lambda *s: torch.randn(*s, dtype=torch.bfloat16) * 0.8)(D, Hq * Dh) * (D ** -0.5)),
            "wo": _w((lambda *s: torch.randn(*s, dtype=torch.bfloat16) * 3.2)(Hq * Dh, D) * ((Hq * Dh) ** -0.5)),
        }
    _A_in = _A_setup()

    def _B_setup():
        B, Sq, D = 8, 1, 448
        Hq, Hkv, Sk, Dh = 16, 8, 4096, 256
        assert Hq % Hkv == 0, (Hq, Hkv)
        return {
            "x": _w((lambda *s: torch.randn(*s, dtype=torch.bfloat16) * 0.1)(B, Sq, D)),
            "k_cache": _w((lambda *s: torch.randn(*s, dtype=torch.bfloat16) * 1.6)(B, Hkv, Sk, Dh)),
            "v_cache": _w((lambda *s: torch.randn(*s, dtype=torch.bfloat16) * 1.6)(B, Hkv, Sk, Dh)),
            "wq": _w((lambda *s: torch.randn(*s, dtype=torch.bfloat16) * 1.6)(D, Hq * Dh) * (D ** -0.5)),
            "wo": _w((lambda *s: torch.randn(*s, dtype=torch.bfloat16) * 1.6)(Hq * Dh, D) * ((Hq * Dh) ** -0.5)),
        }
    _B_in = _B_setup()

    return {
        "A_x": _A_in["x"],
        "A_k_cache": _A_in["k_cache"],
        "A_v_cache": _A_in["v_cache"],
        "A_wq": _A_in["wq"],
        "A_wo": _A_in["wo"],
        "B_x": _B_in["x"],
        "B_k_cache": _B_in["k_cache"],
        "B_v_cache": _B_in["v_cache"],
        "B_wq": _B_in["wq"],
        "B_wo": _B_in["wo"],
    }

def reference(A_x, A_k_cache, A_v_cache, A_wq, A_wo, B_x, B_k_cache, B_v_cache, B_wq, B_wo):
    def _A_ref(x, k_cache, v_cache, wq, wo):
        B, Sq, D = x.shape
        Hq, Dh = 16, 256
        Hkv = k_cache.shape[1]
        rep = Hq // Hkv
        q = (lambda x, *d: x.permute(*d))((x @ wq).reshape(B, Sq, Hq, Dh), 0, 2, 1, 3)
        k = (lambda x, n, axis: torch.repeat_interleave(x, n, dim=axis))(k_cache, rep, axis=1)
        v = (lambda x, n, axis: torch.repeat_interleave(x, n, dim=axis))(v_cache, rep, axis=1)
        scores = torch.einsum("bhqd,bhkd->bhqk", q, k) * (Dh ** -0.5)
        p = _softmax(scores, axis=-1)
        o = torch.einsum("bhqk,bhkd->bhqd", p, v)
        return (lambda x, *d: x.permute(*d))(o, 0, 2, 1, 3).reshape(B, Sq, Hq * Dh) @ wo

    def _B_ref(x, k_cache, v_cache, wq, wo):
        B, Sq, D = x.shape
        Hq, Dh = 16, 256
        Hkv = k_cache.shape[1]
        rep = Hq // Hkv
        q = (lambda x, *d: x.permute(*d))((x @ wq).reshape(B, Sq, Hq, Dh), 0, 2, 1, 3)
        k = (lambda x, n, axis: torch.repeat_interleave(x, n, dim=axis))(k_cache, rep, axis=1)
        v = (lambda x, n, axis: torch.repeat_interleave(x, n, dim=axis))(v_cache, rep, axis=1)
        scores = torch.einsum("bhqd,bhkd->bhqk", q, k) * (Dh ** -0.5)
        p = _softmax(scores, axis=-1)
        o = torch.einsum("bhqk,bhkd->bhqd", p, v)
        return (lambda x, *d: x.permute(*d))(o, 0, 2, 1, 3).reshape(B, Sq, Hq * Dh) @ wo

    x = A_x
    x = x + _A_ref(_layernorm(x, axis=-1), A_k_cache, A_v_cache, A_wq, A_wo)
    x = x + _B_ref(_layernorm(x, axis=-1), B_k_cache, B_v_cache, B_wq, B_wo)
    x = x + _A_ref(_layernorm(x, axis=-1), A_k_cache, A_v_cache, A_wq, A_wo)
    x = x + _B_ref(_layernorm(x, axis=-1), B_k_cache, B_v_cache, B_wq, B_wo)
    return x
```

```asm
; @launch grid=(256,1,1) block=(256,1,1) lds=102656
.amdgcn_target "amdgcn-amd-amdhsa--gfx950"
.text
.globl interleave_layers__gqa_block_cached__gqa_block_cached__decode_kernel
.p2align 8
.type interleave_layers__gqa_block_cached__gqa_block_cached__decode_kernel,@function
interleave_layers__gqa_block_cached__gqa_block_cached__decode_kernel:
s_cmp_ge_u32 s2, 256
s_cbranch_scc1 L_end
s_load_dwordx16 s[16:31], s[0:1], 0
s_load_dwordx8 s[32:39], s[0:1], 64
s_load_dwordx2 s[40:41], s[0:1], 96
s_mov_b32 s74, s2
s_and_b32 s66, s2, 7
s_lshr_b32 s67, s2, 3
v_and_b32 v32, 63, v0
v_lshrrev_b32 v35, 6, v0
v_and_b32 v33, 15, v32
v_lshrrev_b32 v34, 4, v32
v_readfirstlane_b32 s65, v35
s_lshl_b32 s90, s66, 21
s_mov_b32 s91, s67
s_lshl_b32 s91, s91, 16
s_add_u32 s90, s90, s91
s_lshl_b32 s91, s65, 14
s_add_u32 s90, s90, s91
v_lshrrev_b32 v36, 3, v33
v_lshlrev_b32 v36, 11, v36
v_bfe_u32 v37, v33, 2, 1
v_lshl_add_u32 v36, v37, 12, v36
v_bfe_u32 v37, v33, 1, 1
v_lshl_add_u32 v36, v37, 10, v36
v_and_b32 v37, 1, v33
v_lshl_add_u32 v36, v37, 6, v36
v_lshl_add_u32 v36, v34, 4, v36
v_add_u32 v1, s90, v36
v_lshrrev_b32 v36, 1, v34
v_lshlrev_b32 v36, 12, v36
v_and_b32 v37, 1, v34
v_lshl_add_u32 v36, v37, 9, v36
v_lshl_add_u32 v36, v33, 4, v36
v_add_u32 v2, s90, v36
s_mov_b32 s68, 0
s_mov_b32 s69, 8192
s_waitcnt lgkmcnt(0)
s_mov_b32 s44, s18
s_mov_b32 s45, s19
s_mov_b32 s47, 0x00020000
s_mov_b32 s48, s20
s_mov_b32 s49, s21
s_mov_b32 s51, 0x00020000
s_mov_b32 s52, s40
s_mov_b32 s53, s41
s_mov_b32 s55, 0x00020000
s_mov_b32 s56, s36
s_mov_b32 s57, s37
s_mov_b32 s59, 0x00020000
s_mov_b32 s46, 0x08000000
s_mov_b32 s50, 0x08000000
s_mov_b32 s54, 67108864
s_mov_b32 s58, 7168
s_mul_i32 s91, s2, 4640
v_lshlrev_b32 v36, 4, v0
v_add_u32 v36, s91, v36
v_mov_b32 v40, -1
v_mov_b32 v41, -1
v_mov_b32 v42, -1
v_mov_b32 v43, -1
buffer_store_dwordx4 v[40:43], v36, s[52:55], 0 offen sc1
v_add_u32 v37, 4096, v36
v_cmp_gt_u32 vcc, 34, v0
v_mov_b32 v38, 0x7fff0000
s_nop 0
v_cndmask_b32 v37, v38, v37, vcc
buffer_store_dwordx4 v[40:43], v37, s[52:55], 0 offen sc1
s_lshl_b32 s91, s2, 7
s_add_u32 s91, s91, 12288
v_mov_b32 v37, s91
s_mov_b64 exec, 1
buffer_store_dword v40, v37, s[52:55], 0 offen sc1
s_mov_b64 exec, -1
s_and_b32 s26, s67, 1
s_lshr_b32 s27, s67, 1
v_lshrrev_b32 v44, 1, v32
v_lshlrev_b32 v44, 13, v44
v_and_b32 v45, 1, v32
v_lshl_add_u32 v44, v45, 4, v44
s_lshl_b32 s91, s66, 10
s_lshl_b32 s92, s27, 6
s_add_u32 s91, s91, s92
s_lshl_b32 s92, s65, 18
s_add_u32 s91, s91, s92
v_add_u32 v44, s91, v44
s_mov_b32 s92, 0
s_mov_b32 s93, 1048576
s_mov_b32 s94, 2097152
s_mov_b32 s95, 3145728
s_cmp_lg_u32 s26, 0
s_cselect_b32 s60, s32, s22
s_cselect_b32 s61, s33, s23
s_mov_b32 s62, 3670016
s_mov_b32 s63, 0x00020000
buffer_load_dwordx4 v[48:51], v44, s[60:63], s92 offen
buffer_load_dwordx4 v[52:55], v44, s[60:63], s93 offen
buffer_load_dwordx4 v[56:59], v44, s[60:63], s94 offen
buffer_load_dwordx4 v[60:63], v44, s[60:63], s95 offen
buffer_load_dwordx4 v[72:75], v44, s[60:63], s92 offen offset:32
buffer_load_dwordx4 v[76:79], v44, s[60:63], s93 offen offset:32
buffer_load_dwordx4 v[80:83], v44, s[60:63], s94 offen offset:32
buffer_load_dwordx4 v[84:87], v44, s[60:63], s95 offen offset:32
s_mov_b32 s60, s16
s_mov_b32 s61, s17
s_mov_b32 s62, 7168
s_mov_b32 s63, 0x00020000
v_lshlrev_b32 v46, 4, v0
buffer_load_dwordx4 v[64:67], v46, s[60:63], 0 offen
v_add_u32 v47, 4096, v46
buffer_load_dwordx4 v[68:71], v47, s[60:63], 0 offen
buffer_load_dwordx4 a[0:3], v1, s[44:47], s68 offen offset:0 nt
buffer_load_dwordx4 a[4:7], v1, s[44:47], s68 offen offset:128 nt
buffer_load_dwordx4 a[8:11], v1, s[44:47], s68 offen offset:256 nt
buffer_load_dwordx4 a[12:15], v1, s[44:47], s68 offen offset:384 nt
buffer_load_dwordx4 a[16:19], v1, s[44:47], s68 offen offset:512 nt
buffer_load_dwordx4 a[20:23], v1, s[44:47], s68 offen offset:640 nt
buffer_load_dwordx4 a[24:27], v1, s[44:47], s68 offen offset:768 nt
buffer_load_dwordx4 a[28:31], v1, s[44:47], s68 offen offset:896 nt
s_and_b32 s4, s65, 1
s_lshr_b32 s5, s65, 1
s_and_b32 s6, s27, 1
s_lshr_b32 s7, s27, 1
v_lshlrev_b32 v36, 4, v32
s_lshl_b32 s90, s66, 16
s_lshl_b32 s91, s4, 14
s_add_u32 s90, s90, s91
s_lshl_b32 s91, s67, 8
s_add_u32 s90, s90, s91
v_lshrrev_b32 v37, 5, v32
v_lshlrev_b32 v37, 13, v37
v_and_b32 v38, 31, v32
v_lshl_add_u32 v37, v38, 3, v37
v_add_u32 v3, s90, v37
s_lshl_b32 s90, s66, 16
s_lshl_b32 s91, s5, 15
s_add_u32 s90, s90, s91
s_lshl_b32 s91, s6, 14
s_add_u32 s90, s90, s91
s_lshl_b32 s91, s4, 13
s_add_u32 s90, s90, s91
v_add_u32 v4, s90, v36
s_lshl_b32 s90, s66, 9
s_lshl_b32 s91, s5, 8
s_add_u32 s90, s90, s91
s_lshl_b32 s91, s6, 7
s_add_u32 s90, s90, s91
v_lshlrev_b32 v37, 5, v34
v_add_u32 v5, s90, v37
s_lshl_b32 s90, s66, 9
s_lshl_b32 s91, s4, 7
s_add_u32 s90, s90, s91
s_bfe_u32 s91, s67, 0x10002
s_lshl_b32 s91, s91, 6
s_add_u32 s90, s90, s91
s_bfe_u32 s91, s67, 0x10001
s_lshl_b32 s91, s91, 5
s_add_u32 s90, s90, s91
s_lshr_b32 s91, s67, 3
s_lshl_b32 s91, s91, 3
s_add_u32 s90, s90, s91
s_and_b32 s91, s67, 1
s_lshl_b32 s91, s91, 2
s_add_u32 s90, s90, s91
v_mov_b32 v6, s90
s_mul_i32 s90, s7, 56
s_lshl_b32 s91, s65, 4
s_add_u32 s90, s90, s91
v_and_b32 v37, 1, v33
s_movk_i32 s91, 448
v_mul_lo_u32 v37, v37, s91
v_lshl_add_u32 v37, v34, 2, v37
v_add_u32 v37, s90, v37
v_lshrrev_b32 v38, 7, v37
v_lshlrev_b32 v38, 12, v38
v_and_b32 v37, 127, v37
v_lshl_add_u32 v37, v37, 1, v38
s_lshl_b32 s90, s66, 1
s_add_u32 s90, s90, s6
s_lshl_b32 s90, s90, 8
v_add_u32 v7, s90, v37
s_lshl_b32 s90, s65, 12
v_add_u32 v8, s90, v36
s_add_u32 s91, s65, 4
s_cmp_eq_u32 s65, 3
s_cselect_b32 s8, 3, s91
s_lshl_b32 s90, s8, 12
v_add_u32 v9, s90, v36
s_lshl_b32 s90, s66, 10
s_lshl_b32 s91, s27, 6
s_add_u32 s90, s90, s91
s_lshl_b32 s91, s4, 5
s_add_u32 s90, s90, s91
v_and_b32 v37, 1, v33
v_lshlrev_b32 v37, 13, v37
v_lshl_add_u32 v37, v34, 3, v37
v_add_u32 v10, s90, v37
s_lshl_b32 s90, s66, 10
v_add_u32 v11, s90, v36
s_lshl_b32 s90, s65, 11
s_add_u32 s90, s90, 81920
v_add_u32 v12, s90, v36
v_lshrrev_b32 v37, 3, v33
v_lshlrev_b32 v37, 9, v37
v_lshl_add_u32 v37, v34, 4, v37
v_and_b32 v38, 1, v33
v_lshl_add_u32 v37, v38, 6, v37
v_add_u32 v13, s90, v37
s_lshl_b32 s90, s65, 12
s_add_u32 s90, s90, 65536
v_lshrrev_b32 v37, 1, v34
v_lshlrev_b32 v37, 10, v37
v_lshl_add_u32 v37, v33, 5, v37
v_and_b32 v38, 1, v34
v_lshl_add_u32 v37, v38, 4, v37
v_add_u32 v14, s90, v37
s_lshl_b32 s90, s65, 3
s_add_u32 s90, s90, 102400
v_lshrrev_b32 v37, 3, v33
v_lshlrev_b32 v37, 5, v37
v_add_u32 v15, s90, v37
s_lshl_b32 s90, s65, 10
s_add_u32 s90, s90, 65536
v_add_u32 v16, s90, v36
s_lshl_b32 s90, s65, 5
s_add_u32 s90, s90, 102400
v_mov_b32 v17, s90
s_lshl_b32 s90, s5, 9
s_lshl_b32 s91, s4, 8
s_add_u32 s90, s90, s91
s_add_u32 s90, s90, 101376
v_and_b32 v38, 1, v34
v_lshlrev_b32 v37, 4, v33
v_lshl_add_u32 v39, v38, 3, v37
v_add_u32 v18, s90, v39
s_lshl_b32 s90, s65, 8
s_add_u32 s90, s90, 98304
v_add_u32 v23, s90, v39
s_lshl_b32 s90, s8, 8
s_add_u32 s90, s90, 98304
v_add_u32 v24, s90, v39
v_and_b32 v37, 1, v33
v_lshlrev_b32 v37, 9, v37
v_lshl_add_u32 v37, v34, 4, v37
v_add_u32 v19, 101376, v37
v_lshlrev_b32 v37, 8, v34
v_lshl_add_u32 v37, v33, 3, v37
s_lshl_b32 s90, s4, 14
s_add_u32 s90, s90, 0
v_add_u32 v21, s90, v37
s_lshl_b32 s90, s65, 13
s_add_u32 s90, s90, 32768
v_add_u32 v20, s90, v37
v_and_b32 v37, 3, v33
v_min_u32 v37, 2, v37
s_movk_i32 s91, 896
v_mul_lo_u32 v37, v37, s91
v_lshl_add_u32 v37, v34, 4, v37
v_add_u32 v22, 98304, v37
v_and_b32 v37, 1, v33
v_cmp_eq_u32 vcc, 1, v37
v_mov_b32 v38, 0xffff
v_mov_b32 v39, 0xffff0000
v_cndmask_b32 v38, v38, v39, vcc
v_lshrrev_b32 v37, 1, v33
v_and_b32 v37, 3, v37
v_cmp_eq_u32 vcc, 0, v37
s_nop 1
v_cndmask_b32 v25, 0, v38, vcc
v_cmp_eq_u32 vcc, 1, v37
s_nop 1
v_cndmask_b32 v26, 0, v38, vcc
v_cmp_eq_u32 vcc, 2, v37
s_nop 1
v_cndmask_b32 v27, 0, v38, vcc
v_cmp_eq_u32 vcc, 3, v37
s_nop 1
v_cndmask_b32 v28, 0, v38, vcc
s_waitcnt vmcnt(18)
s_barrier
s_cmp_lg_u32 s65, 0
s_cbranch_scc1 L_noatomic
s_mov_b32 s4, s38
s_mov_b32 s5, s39
s_mov_b32 s6, 256
s_mov_b32 s7, 0x00020000
s_lshl_b32 s90, s66, 5
v_mov_b32 v36, s90
s_getreg_b32 s91, hwreg(HW_REG_XCC_ID)
s_and_b32 s91, s91, 15
s_mul_i32 s90, s91, s91
s_lshl_b32 s90, s90, 18
s_lshl_b32 s91, s91, 8
s_add_u32 s91, s91, s90
s_add_u32 s91, s91, 1
v_mov_b32 v37, s91
s_mov_b64 exec, 1
buffer_atomic_add v37, v36, s[4:7], 0 offen sc1
s_mov_b64 exec, -1
L_noatomic:
buffer_load_dwordx4 a[32:35], v1, s[44:47], s69 offen offset:0 nt
buffer_load_dwordx4 a[36:39], v1, s[44:47], s69 offen offset:128 nt
buffer_load_dwordx4 a[40:43], v1, s[44:47], s69 offen offset:256 nt
buffer_load_dwordx4 a[44:47], v1, s[44:47], s69 offen offset:384 nt
buffer_load_dwordx4 a[48:51], v1, s[44:47], s69 offen offset:512 nt
buffer_load_dwordx4 a[52:55], v1, s[44:47], s69 offen offset:640 nt
buffer_load_dwordx4 a[56:59], v1, s[44:47], s69 offen offset:768 nt
buffer_load_dwordx4 a[60:63], v1, s[44:47], s69 offen offset:896 nt
s_cmp_lg_u32 s74, 0
s_cbranch_scc1 L_nofin
s_cmp_lg_u32 s65, 1
s_cbranch_scc1 L_nofin
s_mov_b32 s88, 0
L_fpoll:
s_load_dword s4, s[38:39], 0 glc
s_load_dword s5, s[38:39], 32 glc
s_load_dword s6, s[38:39], 64 glc
s_load_dword s7, s[38:39], 96 glc
s_load_dword s8, s[38:39], 128 glc
s_load_dword s9, s[38:39], 160 glc
s_load_dword s10, s[38:39], 192 glc
s_load_dword s11, s[38:39], 224 glc
s_waitcnt lgkmcnt(0)
s_and_b32 s12, s4, s5
s_and_b32 s13, s6, s7
s_and_b32 s14, s8, s9
s_and_b32 s15, s10, s11
s_and_b32 s12, s12, s13
s_and_b32 s14, s14, s15
s_and_b32 s12, s12, s14
s_bitcmp1_b32 s12, 5
s_cbranch_scc1 L_fdone
s_add_u32 s88, s88, 1
s_cmp_lt_u32 s88, 200000
s_cbranch_scc1 L_fpoll
L_fdone:
s_mov_b32 s12, 0x100
s_lshr_b32 s13, s4, 8
s_and_b32 s13, s13, 0x3ff
s_mul_i32 s13, s13, s13
s_lshr_b32 s14, s4, 18
s_lshl_b32 s14, s14, 5
s_cmp_eq_u32 s13, s14
s_cselect_b32 s13, 1, 0
s_or_b32 s12, s12, s13
s_lshr_b32 s13, s5, 8
s_and_b32 s13, s13, 0x3ff
s_mul_i32 s13, s13, s13
s_lshr_b32 s14, s5, 18
s_lshl_b32 s14, s14, 5
s_cmp_eq_u32 s13, s14
s_cselect_b32 s13, 2, 0
s_or_b32 s12, s12, s13
s_lshr_b32 s13, s6, 8
s_and_b32 s13, s13, 0x3ff
s_mul_i32 s13, s13, s13
s_lshr_b32 s14, s6, 18
s_lshl_b32 s14, s14, 5
s_cmp_eq_u32 s13, s14
s_cselect_b32 s13, 4, 0
s_or_b32 s12, s12, s13
s_lshr_b32 s13, s7, 8
s_and_b32 s13, s13, 0x3ff
s_mul_i32 s13, s13, s13
s_lshr_b32 s14, s7, 18
s_lshl_b32 s14, s14, 5
s_cmp_eq_u32 s13, s14
s_cselect_b32 s13, 8, 0
s_or_b32 s12, s12, s13
s_lshr_b32 s13, s8, 8
s_and_b32 s13, s13, 0x3ff
s_mul_i32 s13, s13, s13
s_lshr_b32 s14, s8, 18
s_lshl_b32 s14, s14, 5
s_cmp_eq_u32 s13, s14
s_cselect_b32 s13, 16, 0
s_or_b32 s12, s12, s13
s_lshr_b32 s13, s9, 8
s_and_b32 s13, s13, 0x3ff
s_mul_i32 s13, s13, s13
s_lshr_b32 s14, s9, 18
s_lshl_b32 s14, s14, 5
s_cmp_eq_u32 s13, s14
s_cselect_b32 s13, 32, 0
s_or_b32 s12, s12, s13
s_lshr_b32 s13, s10, 8
s_and_b32 s13, s13, 0x3ff
s_mul_i32 s13, s13, s13
s_lshr_b32 s14, s10, 18
s_lshl_b32 s14, s14, 5
s_cmp_eq_u32 s13, s14
s_cselect_b32 s13, 64, 0
s_or_b32 s12, s12, s13
s_lshr_b32 s13, s11, 8
s_and_b32 s13, s13, 0x3ff
s_mul_i32 s13, s13, s13
s_lshr_b32 s14, s11, 18
s_lshl_b32 s14, s14, 5
s_cmp_eq_u32 s13, s14
s_cselect_b32 s13, 128, 0
s_or_b32 s12, s12, s13
v_mov_b32 v37, s12
v_lshlrev_b32 v36, 7, v32
v_add_u32 v38, 12288, v36
buffer_store_dword v37, v38, s[52:55], 0 offen sc1
v_add_u32 v38, 20480, v36
buffer_store_dword v37, v38, s[52:55], 0 offen sc1
v_add_u32 v38, 28672, v36
buffer_store_dword v37, v38, s[52:55], 0 offen sc1
v_add_u32 v38, 36864, v36
buffer_store_dword v37, v38, s[52:55], 0 offen sc1
L_nofin:
s_and_b32 s90, s27, 1
s_lshl_b32 s91, s66, 1
s_add_u32 s91, s91, s90
s_lshl_b32 s91, s91, 8
s_lshr_b32 s90, s65, 1
s_lshl_b32 s90, s90, 7
s_add_u32 s91, s91, s90
s_mul_i32 s91, s91, 896
s_lshr_b32 s90, s27, 1
s_mul_i32 s90, s90, 112
s_add_u32 s91, s91, s90
s_and_b32 s90, s65, 1
s_lshl_b32 s90, s90, 5
s_add_u32 s91, s91, s90
v_lshrrev_b32 v45, 1, v32
s_movk_i32 s90, 896
v_mul_lo_u32 v45, v45, s90
v_and_b32 v46, 1, v32
v_lshl_add_u32 v45, v46, 4, v45
v_add_u32 v45, s91, v45
s_mov_b32 s92, 0
s_mov_b32 s93, 28672
s_mov_b32 s94, 57344
s_mov_b32 s95, 86016
s_cmp_lg_u32 s26, 0
s_cselect_b32 s60, s34, s24
s_cselect_b32 s61, s35, s25
s_mov_b32 s62, 3670016
s_mov_b32 s63, 0x00020000
buffer_load_dwordx4 v[88:91], v45, s[60:63], s92 offen
buffer_load_dwordx4 v[92:95], v45, s[60:63], s93 offen
buffer_load_dwordx4 v[96:99], v45, s[60:63], s94 offen
buffer_load_dwordx4 v[100:103], v45, s[60:63], s95 offen
buffer_load_dwordx4 v[104:107], v45, s[60:63], s92 offen offset:64
buffer_load_dwordx4 v[108:111], v45, s[60:63], s93 offen offset:64
buffer_load_dwordx4 v[112:115], v45, s[60:63], s94 offen offset:64
buffer_load_dwordx4 v[116:119], v45, s[60:63], s95 offen offset:64
s_mov_b32 s60, s16
s_mov_b32 s61, s17
s_mov_b32 s62, 7168
s_mov_b32 s63, 0x00020000
v_accvgpr_write_b32 a128, 0
v_accvgpr_write_b32 a129, 0
v_accvgpr_write_b32 a130, 0
v_accvgpr_write_b32 a131, 0
v_accvgpr_write_b32 a132, 0
v_accvgpr_write_b32 a133, 0
v_accvgpr_write_b32 a134, 0
v_accvgpr_write_b32 a135, 0
v_accvgpr_write_b32 a136, 0
v_accvgpr_write_b32 a137, 0
v_accvgpr_write_b32 a138, 0
v_accvgpr_write_b32 a139, 0
v_accvgpr_write_b32 a140, 0
v_accvgpr_write_b32 a141, 0
v_accvgpr_write_b32 a142, 0
v_accvgpr_write_b32 a143, 0
v_accvgpr_write_b32 a144, 0
v_accvgpr_write_b32 a145, 0
v_accvgpr_write_b32 a146, 0
v_accvgpr_write_b32 a147, 0
v_accvgpr_write_b32 a148, 0
v_accvgpr_write_b32 a149, 0
v_accvgpr_write_b32 a150, 0
v_accvgpr_write_b32 a151, 0
v_accvgpr_write_b32 a152, 0
v_accvgpr_write_b32 a153, 0
v_accvgpr_write_b32 a154, 0
v_accvgpr_write_b32 a155, 0
v_accvgpr_write_b32 a156, 0
v_accvgpr_write_b32 a157, 0
v_accvgpr_write_b32 a158, 0
v_accvgpr_write_b32 a159, 0
v_accvgpr_write_b32 a160, 0
v_accvgpr_write_b32 a161, 0
v_accvgpr_write_b32 a162, 0
v_accvgpr_write_b32 a163, 0
v_accvgpr_write_b32 a164, 0
v_accvgpr_write_b32 a165, 0
v_accvgpr_write_b32 a166, 0
v_accvgpr_write_b32 a167, 0
v_accvgpr_write_b32 a168, 0
v_accvgpr_write_b32 a169, 0
v_accvgpr_write_b32 a170, 0
v_accvgpr_write_b32 a171, 0
v_accvgpr_write_b32 a172, 0
v_accvgpr_write_b32 a173, 0
v_accvgpr_write_b32 a174, 0
v_accvgpr_write_b32 a175, 0
v_accvgpr_write_b32 a176, 0
v_accvgpr_write_b32 a177, 0
v_accvgpr_write_b32 a178, 0
v_accvgpr_write_b32 a179, 0
v_accvgpr_write_b32 a180, 0
v_accvgpr_write_b32 a181, 0
v_accvgpr_write_b32 a182, 0
v_accvgpr_write_b32 a183, 0
v_accvgpr_write_b32 a184, 0
v_accvgpr_write_b32 a185, 0
v_accvgpr_write_b32 a186, 0
v_accvgpr_write_b32 a187, 0
v_accvgpr_write_b32 a188, 0
v_accvgpr_write_b32 a189, 0
v_accvgpr_write_b32 a190, 0
v_accvgpr_write_b32 a191, 0
v_accvgpr_write_b32 a192, 0
v_accvgpr_write_b32 a193, 0
v_accvgpr_write_b32 a194, 0
v_accvgpr_write_b32 a195, 0
v_accvgpr_write_b32 a196, 0
v_accvgpr_write_b32 a197, 0
v_accvgpr_write_b32 a198, 0
v_accvgpr_write_b32 a199, 0
v_accvgpr_write_b32 a200, 0
v_accvgpr_write_b32 a201, 0
v_accvgpr_write_b32 a202, 0
v_accvgpr_write_b32 a203, 0
v_accvgpr_write_b32 a204, 0
v_accvgpr_write_b32 a205, 0
v_accvgpr_write_b32 a206, 0
v_accvgpr_write_b32 a207, 0
v_accvgpr_write_b32 a208, 0
v_accvgpr_write_b32 a209, 0
v_accvgpr_write_b32 a210, 0
v_accvgpr_write_b32 a211, 0
v_accvgpr_write_b32 a212, 0
v_accvgpr_write_b32 a213, 0
v_accvgpr_write_b32 a214, 0
v_accvgpr_write_b32 a215, 0
v_accvgpr_write_b32 a216, 0
v_accvgpr_write_b32 a217, 0
v_accvgpr_write_b32 a218, 0
v_accvgpr_write_b32 a219, 0
v_accvgpr_write_b32 a220, 0
v_accvgpr_write_b32 a221, 0
v_accvgpr_write_b32 a222, 0
v_accvgpr_write_b32 a223, 0
v_accvgpr_write_b32 a224, 0
v_accvgpr_write_b32 a225, 0
v_accvgpr_write_b32 a226, 0
v_accvgpr_write_b32 a227, 0
v_accvgpr_write_b32 a228, 0
v_accvgpr_write_b32 a229, 0
v_accvgpr_write_b32 a230, 0
v_accvgpr_write_b32 a231, 0
v_accvgpr_write_b32 a232, 0
v_accvgpr_write_b32 a233, 0
v_accvgpr_write_b32 a234, 0
v_accvgpr_write_b32 a235, 0
v_accvgpr_write_b32 a236, 0
v_accvgpr_write_b32 a237, 0
v_accvgpr_write_b32 a238, 0
v_accvgpr_write_b32 a239, 0
v_accvgpr_write_b32 a240, 0
v_accvgpr_write_b32 a241, 0
v_accvgpr_write_b32 a242, 0
v_accvgpr_write_b32 a243, 0
v_accvgpr_write_b32 a244, 0
v_accvgpr_write_b32 a245, 0
v_accvgpr_write_b32 a246, 0
v_accvgpr_write_b32 a247, 0
v_accvgpr_write_b32 a248, 0
v_accvgpr_write_b32 a249, 0
v_accvgpr_write_b32 a250, 0
v_accvgpr_write_b32 a251, 0
v_accvgpr_write_b32 a252, 0
v_accvgpr_write_b32 a253, 0
v_accvgpr_write_b32 a254, 0
v_accvgpr_write_b32 a255, 0
v_mov_b32 v128, 0
v_mov_b32 v129, 0
v_mov_b32 v130, 0
v_mov_b32 v131, 0
v_mov_b32 v132, 0
v_mov_b32 v133, 0
v_mov_b32 v134, 0
v_mov_b32 v135, 0
v_mov_b32 v136, 0
v_mov_b32 v137, 0
v_mov_b32 v138, 0
v_mov_b32 v139, 0
v_mov_b32 v140, 0
v_mov_b32 v141, 0
v_mov_b32 v142, 0
v_mov_b32 v143, 0
v_mov_b32 v144, 0
v_mov_b32 v145, 0
v_mov_b32 v146, 0
v_mov_b32 v147, 0
v_mov_b32 v148, 0
v_mov_b32 v149, 0
v_mov_b32 v150, 0
v_mov_b32 v151, 0
v_mov_b32 v152, 0
v_mov_b32 v153, 0
v_mov_b32 v154, 0
v_mov_b32 v155, 0
v_mov_b32 v156, 0
v_mov_b32 v157, 0
v_mov_b32 v158, 0
v_mov_b32 v159, 0
v_mov_b32 v160, 0
v_mov_b32 v161, 0
v_mov_b32 v162, 0
v_mov_b32 v163, 0
v_mov_b32 v164, 0
v_mov_b32 v165, 0
v_mov_b32 v166, 0
v_mov_b32 v167, 0
v_mov_b32 v168, 0
v_mov_b32 v169, 0
v_mov_b32 v170, 0
v_mov_b32 v171, 0
v_mov_b32 v172, 0
v_mov_b32 v173, 0
v_mov_b32 v174, 0
v_mov_b32 v175, 0
v_mov_b32 v176, 0
v_mov_b32 v177, 0
v_mov_b32 v178, 0
v_mov_b32 v179, 0
v_mov_b32 v180, 0
v_mov_b32 v181, 0
v_mov_b32 v182, 0
v_mov_b32 v183, 0
v_mov_b32 v184, 0
v_mov_b32 v185, 0
v_mov_b32 v186, 0
v_mov_b32 v187, 0
v_mov_b32 v188, 0
v_mov_b32 v189, 0
v_mov_b32 v190, 0
v_mov_b32 v191, 0
v_mov_b32 v192, 0
v_mov_b32 v193, 0
v_mov_b32 v194, 0
v_mov_b32 v195, 0
v_mov_b32 v196, 0
v_mov_b32 v197, 0
v_mov_b32 v198, 0
v_mov_b32 v199, 0
v_mov_b32 v200, 0
v_mov_b32 v201, 0
v_mov_b32 v202, 0
v_mov_b32 v203, 0
v_mov_b32 v204, 0
v_mov_b32 v205, 0
v_mov_b32 v206, 0
v_mov_b32 v207, 0
v_mov_b32 v208, 0
v_mov_b32 v209, 0
v_mov_b32 v210, 0
v_mov_b32 v211, 0
v_mov_b32 v212, 0
v_mov_b32 v213, 0
v_mov_b32 v214, 0
v_mov_b32 v215, 0
v_mov_b32 v216, 0
v_mov_b32 v217, 0
v_mov_b32 v218, 0
v_mov_b32 v219, 0
v_mov_b32 v220, 0
v_mov_b32 v221, 0
v_mov_b32 v222, 0
v_mov_b32 v223, 0
v_mov_b32 v224, 0
v_mov_b32 v225, 0
v_mov_b32 v226, 0
v_mov_b32 v227, 0
v_mov_b32 v228, 0
v_mov_b32 v229, 0
v_mov_b32 v230, 0
v_mov_b32 v231, 0
v_mov_b32 v232, 0
v_mov_b32 v233, 0
v_mov_b32 v234, 0
v_mov_b32 v235, 0
v_mov_b32 v236, 0
v_mov_b32 v237, 0
v_mov_b32 v238, 0
v_mov_b32 v239, 0
v_mov_b32 v240, 0
v_mov_b32 v241, 0
v_mov_b32 v242, 0
v_mov_b32 v243, 0
v_mov_b32 v244, 0
v_mov_b32 v245, 0
v_mov_b32 v246, 0
v_mov_b32 v247, 0
v_mov_b32 v248, 0
v_mov_b32 v249, 0
v_mov_b32 v250, 0
v_mov_b32 v251, 0
v_mov_b32 v252, 0
v_mov_b32 v253, 0
v_mov_b32 v254, 0
v_mov_b32 v255, 0
s_waitcnt vmcnt(24)
v_lshlrev_b32 v36, 4, v32
s_lshl_b32 s90, s65, 10
v_add_u32 v36, s90, v36
ds_write_b128 v36, v[48:51] offset:0
ds_write_b128 v36, v[52:55] offset:4096
ds_write_b128 v36, v[56:59] offset:8192
ds_write_b128 v36, v[60:63] offset:12288
ds_write_b128 v36, v[72:75] offset:16384
ds_write_b128 v36, v[76:79] offset:20480
ds_write_b128 v36, v[80:83] offset:24576
ds_write_b128 v36, v[84:87] offset:28672
v_lshlrev_b32 v46, 4, v0
v_add_u32 v47, 90112, v46
ds_write_b128 v47, v[64:67] offset:0
ds_write_b128 v47, v[68:71] offset:4096
v_add_u32 v47, 98304, v46
v_cmp_gt_u32 vcc, 112, v0
s_and_saveexec_b64 s[90:91], vcc
ds_write_b128 v47, v[64:67]
s_mov_b64 exec, -1
s_nop 0
v_mov_b32 v64, 0x3f803f80
v_mov_b32 v65, v64
v_mov_b32 v66, v64
v_mov_b32 v67, v64
v_subrev_u32 v46, 192, v0
v_cmp_gt_u32 vcc, 56, v46
v_lshlrev_b32 v46, 4, v46
v_add_u32 v47, 100096, v46
s_and_saveexec_b64 s[90:91], vcc
s_cbranch_execz L_noones
ds_write_b128 v47, v[64:67]
L_noones:
s_mov_b64 exec, -1
buffer_load_dwordx4 a[64:67], v2, s[48:51], s68 offen offset:0 nt
buffer_load_dwordx4 a[68:71], v2, s[48:51], s68 offen offset:2048 nt
buffer_load_dwordx4 a[72:75], v2, s[48:51], s68 offen offset:256 nt
buffer_load_dwordx4 a[76:79], v2, s[48:51], s68 offen offset:2304 nt
buffer_load_dwordx4 a[80:83], v2, s[48:51], s68 offen offset:1024 nt
buffer_load_dwordx4 a[84:87], v2, s[48:51], s68 offen offset:3072 nt
buffer_load_dwordx4 a[88:91], v2, s[48:51], s68 offen offset:1280 nt
buffer_load_dwordx4 a[92:95], v2, s[48:51], s68 offen offset:3328 nt
buffer_load_dwordx4 a[96:99], v2, s[48:51], s69 offen offset:0 nt
buffer_load_dwordx4 a[100:103], v2, s[48:51], s69 offen offset:2048 nt
buffer_load_dwordx4 a[104:107], v2, s[48:51], s69 offen offset:256 nt
buffer_load_dwordx4 a[108:111], v2, s[48:51], s69 offen offset:2304 nt
buffer_load_dwordx4 a[112:115], v2, s[48:51], s69 offen offset:1024 nt
buffer_load_dwordx4 a[116:119], v2, s[48:51], s69 offen offset:3072 nt
buffer_load_dwordx4 a[120:123], v2, s[48:51], s69 offen offset:1280 nt
buffer_load_dwordx4 a[124:127], v2, s[48:51], s69 offen offset:3328 nt
s_waitcnt vmcnt(16)
s_and_b32 s90, s65, 1
s_lshl_b32 s90, s90, 13
s_lshr_b32 s91, s65, 1
s_lshl_b32 s91, s91, 12
s_add_u32 s90, s90, s91
v_lshlrev_b32 v37, 4, v32
v_add_u32 v37, s90, v37
ds_write_b128 v37, v[88:91] offset:32768
ds_write_b128 v37, v[92:95] offset:33792
ds_write_b128 v37, v[96:99] offset:34816
ds_write_b128 v37, v[100:103] offset:35840
ds_write_b128 v37, v[104:107] offset:49152
ds_write_b128 v37, v[108:111] offset:50176
ds_write_b128 v37, v[112:115] offset:51200
ds_write_b128 v37, v[116:119] offset:52224
s_mov_b32 s89, 0
s_mov_b32 s24, 0
s_mov_b32 s14, 0x01010101
s_mov_b32 s15, 0x01010101
s_lshl_b32 s90, s27, 7
s_add_u32 s17, s90, 8192
s_waitcnt lgkmcnt(0)
s_cmp_lg_u32 s65, 0
s_cbranch_scc1 L_polled
s_mov_b32 s88, 0
s_lshl_b32 s90, s74, 7
s_add_u32 s90, s90, 12288
L_poll:
s_load_dword s4, s[40:41], s90 glc
s_waitcnt lgkmcnt(0)
s_cmp_lg_u32 s4, -1
s_cbranch_scc1 L_pollx
s_add_u32 s88, s88, 1
s_cmp_lt_u32 s88, 200000
s_cbranch_scc1 L_poll
s_mov_b32 s4, 0
L_pollx:
s_lshr_b32 s4, s4, s66
s_and_b32 s4, s4, 1
v_mov_b32 v36, s4
v_mov_b32 v37, 102528
ds_write_b32 v37, v36
s_waitcnt lgkmcnt(0)
L_polled:
s_barrier
v_mov_b32 v37, 102528
ds_read_b32 v36, v37
s_waitcnt lgkmcnt(0)
v_readfirstlane_b32 s101, v36
s_mov_b32 s64, 0
s_cmp_lg_u32 s26, 0
s_cbranch_scc1 L_top0
s_mov_b32 s64, -1
s_cmp_gt_u32 s65, 1
s_cbranch_scc1 L_qp_2
ds_read_b64_tr_b16 v[96:97], v21 offset:0
ds_read_b64_tr_b16 v[98:99], v21 offset:128
ds_read_b64_tr_b16 v[100:101], v21 offset:1024
ds_read_b64_tr_b16 v[102:103], v21 offset:1152
ds_read_b64_tr_b16 v[104:105], v21 offset:2048
ds_read_b64_tr_b16 v[106:107], v21 offset:2176
ds_read_b64_tr_b16 v[108:109], v21 offset:3072
ds_read_b64_tr_b16 v[110:111], v21 offset:3200
ds_read_b64_tr_b16 v[112:113], v21 offset:4096
ds_read_b64_tr_b16 v[114:115], v21 offset:4224
ds_read_b64_tr_b16 v[116:117], v21 offset:5120
ds_read_b64_tr_b16 v[118:119], v21 offset:5248
s_waitcnt lgkmcnt(6)
ds_read_b64_tr_b16 v[120:121], v21 offset:6144
ds_read_b64_tr_b16 v[122:123], v21 offset:6272
ds_read_b64_tr_b16 v[124:125], v21 offset:7168
ds_read_b64_tr_b16 v[126:127], v21 offset:7296
s_branch L_qp_2
L_top0:
s_lshr_b32 s91, s64, 1
s_and_b32 s91, s91, 1
s_lshl_b32 s91, s91, 13
s_add_u32 s78, s91, 45056
s_xor_b32 s91, s91, 8192
s_add_u32 s77, s91, 45056
s_mov_b32 s88, 0
buffer_load_dwordx4 v[112:115], v11, s[52:55], s77 offen sc1
buffer_load_dwordx4 v[116:119], v11, s[52:55], s78 offen sc1
s_xor_b32 s91, s64, s26
s_and_b32 s23, s91, 1
s_add_u32 s90, s64, 1
s_lshr_b32 s91, s90, 1
s_lshl_b32 s68, s91, 24
s_add_u32 s69, s68, 8192
s_cmp_lt_u32 s90, 16
s_cselect_b32 s92, 0x08000000, 0
s_mov_b32 s46, s92
s_mov_b32 s50, s92
s_cselect_b32 s68, s68, 0
s_cselect_b32 s69, s69, 0
s_bitcmp1_b32 s90, 0
s_cselect_b32 s44, s28, s18
s_cselect_b32 s45, s29, s19
s_cselect_b32 s48, s30, s20
s_cselect_b32 s49, s31, s21
s_mov_b32 s79, 94208
s_mul_i32 s91, s64, 28672
s_add_u32 s80, s91, 106496
s_mov_b32 s81, 661504
s_mov_b32 s82, 665600
s_lshr_b32 s92, s65, 1
s_lshl_b32 s91, s92, 15
s_add_u32 s83, s91, 1185792
s_lshl_b32 s91, s92, 8
s_add_u32 s43, s91, 98304
s_lshr_b32 s86, s64, 1
s_and_b32 s86, s86, 1
s_xor_b32 s93, s86, s92
s_xor_b32 s93, s93, 1
s_lshl_b32 s91, s93, 15
s_add_u32 s84, s81, s91
s_lshl_b32 s91, s93, 8
s_add_u32 s85, s79, s91
s_and_b32 s70, s64, 1
s_xor_b32 s91, s86, 1
s_mul_i32 s71, s91, 896
s_lshr_b32 s91, s64, 1
s_add_u32 s93, s91, 1
s_min_u32 s93, s93, 7
s_mul_i32 s72, s93, 896
s_add_u32 s72, s72, 90112
s_sub_u32 s73, s91, 1
s_mul_i32 s73, s73, 896
s_lshl_b32 s91, s64, 11
s_add_u32 s25, s91, 624640
v_and_b32 v126, 4, v0
v_cmp_eq_u32 vcc, 0, v126
v_mov_b32 v125, 0xffff
s_nop 0
v_cndmask_b32 v122, 0, v125, vcc
v_xor_b32 v123, v122, v125
v_lshlrev_b32 v124, 16, v122
v_lshlrev_b32 v125, 16, v123
v_and_b32 v126, 3, v0
v_mul_u32_u24 v126, 0x5555, v126
v_mov_b32 v120, -1
v_mov_b32 v121, -1
s_cmp_lg_u32 s101, 0
s_cbranch_scc0 L_gs1
buffer_store_dwordx2 v[120:121], v3, s[52:55], s83 offen
s_mov_b64 exec, 1
buffer_store_dword v120, v6, s[52:55], s43 offen
s_mov_b64 exec, -1
L_gsb1:
s_waitcnt vmcnt(2)
v_max3_u32 v120, v112, v113, v114
v_max3_u32 v121, v115, v116, v117
v_max3_u32 v120, v120, v118, v119
v_max_u32 v120, v120, v121
v_cmp_eq_u32 vcc, -1, v120
s_cbranch_vccz L_g3px_0
L_g3p_0:
buffer_load_dwordx4 v[112:115], v11, s[52:55], s77 offen sc1
buffer_load_dwordx4 v[116:119], v11, s[52:55], s78 offen sc1
s_waitcnt vmcnt(0)
v_max3_u32 v120, v112, v113, v114
v_max3_u32 v121, v115, v116, v117
v_max3_u32 v120, v120, v118, v119
v_max_u32 v120, v120, v121
v_cmp_eq_u32 vcc, -1, v120
s_cbranch_vccz L_g3px_0
s_add_u32 s88, s88, 1
s_cmp_lt_u32 s88, 200000
s_cbranch_scc1 L_g3p_0
L_g3px_0:
ds_write_b128 v12, v[112:115]
ds_write_b128 v12, v[116:119] offset:1024
ds_read_b128 v[32:35], v13 offset:0
ds_read_b128 v[36:39], v13 offset:128
ds_read_b128 v[40:43], v13 offset:256
ds_read_b128 v[44:47], v13 offset:384
ds_read_b128 v[48:51], v13 offset:1024
ds_read_b128 v[52:55], v13 offset:1152
ds_read_b128 v[56:59], v13 offset:1280
ds_read_b128 v[60:63], v13 offset:1408
v_mov_b32 v127, 0x3db8aa3b
s_waitcnt lgkmcnt(7)
v_mfma_f32_16x16x32_bf16 v[80:83], a[128:131], v[32:35], 0
v_mfma_f32_16x16x32_bf16 v[84:87], a[144:147], v[32:35], 0
s_waitcnt lgkmcnt(6)
v_mfma_f32_16x16x32_bf16 v[80:83], a[132:135], v[36:39], v[80:83]
v_mfma_f32_16x16x32_bf16 v[84:87], a[148:151], v[36:39], v[84:87]
s_waitcnt lgkmcnt(5)
v_mfma_f32_16x16x32_bf16 v[80:83], a[136:139], v[40:43], v[80:83]
v_mfma_f32_16x16x32_bf16 v[84:87], a[152:155], v[40:43], v[84:87]
s_waitcnt lgkmcnt(4)
v_mfma_f32_16x16x32_bf16 v[80:83], a[140:143], v[44:47], v[80:83]
v_mfma_f32_16x16x32_bf16 v[84:87], a[156:159], v[44:47], v[84:87]
v_mfma_f32_16x16x32_bf16 v[88:91], a[160:163], v[32:35], 0
buffer_load_dwordx4 a[128:131], v1, s[44:47], s68 offen offset:0 nt
v_mfma_f32_16x16x32_bf16 v[92:95], a[176:179], v[32:35], 0
buffer_load_dwordx4 a[132:135], v1, s[44:47], s68 offen offset:128 nt
v_mfma_f32_16x16x32_bf16 v[88:91], a[164:167], v[36:39], v[88:91]
buffer_load_dwordx4 a[136:139], v1, s[44:47], s68 offen offset:256 nt
v_mfma_f32_16x16x32_bf16 v[92:95], a[180:183], v[36:39], v[92:95]
buffer_load_dwordx4 a[140:143], v1, s[44:47], s68 offen offset:384 nt
v_mfma_f32_16x16x32_bf16 v[88:91], a[168:171], v[40:43], v[88:91]
buffer_load_dwordx4 a[144:147], v1, s[44:47], s68 offen offset:512 nt
v_mfma_f32_16x16x32_bf16 v[92:95], a[184:187], v[40:43], v[92:95]
buffer_load_dwordx4 a[148:151], v1, s[44:47], s68 offen offset:640 nt
v_mfma_f32_16x16x32_bf16 v[88:91], a[172:175], v[44:47], v[88:91]
buffer_load_dwordx4 a[152:155], v1, s[44:47], s68 offen offset:768 nt
v_mfma_f32_16x16x32_bf16 v[92:95], a[188:191], v[44:47], v[92:95]
s_waitcnt lgkmcnt(3)
v_mfma_f32_16x16x32_bf16 v[96:99], a[0:3], v[48:51], 0
v_add_f32_dpp v64, v81, v80 quad_perm:[1,0,3,2] row_mask:0xf bank_mask:0xf
v_add_f32_dpp v65, v85, v84 quad_perm:[1,0,3,2] row_mask:0xf bank_mask:0xf
v_mfma_f32_16x16x32_bf16 v[100:103], a[16:19], v[48:51], 0
v_add_f32_dpp v66, v83, v82 quad_perm:[1,0,3,2] row_mask:0xf bank_mask:0xf
v_add_f32_dpp v67, v87, v86 quad_perm:[1,0,3,2] row_mask:0xf bank_mask:0xf
v_mfma_f32_16x16x32_bf16 v[104:107], a[32:35], v[48:51], 0
v_add_f32_dpp v68, v89, v88 quad_perm:[1,0,3,2] row_mask:0xf bank_mask:0xf
v_add_f32_dpp v69, v93, v92 quad_perm:[1,0,3,2] row_mask:0xf bank_mask:0xf
v_mfma_f32_16x16x32_bf16 v[108:111], a[48:51], v[48:51], 0
v_add_f32_dpp v70, v91, v90 quad_perm:[1,0,3,2] row_mask:0xf bank_mask:0xf
v_add_f32_dpp v71, v95, v94 quad_perm:[1,0,3,2] row_mask:0xf bank_mask:0xf
s_waitcnt lgkmcnt(2)
v_mfma_f32_16x16x32_bf16 v[96:99], a[4:7], v[52:55], v[96:99]
v_max3_f32 v112, v64, v65, v66
v_max3_f32 v116, v67, v68, v69
v_mfma_f32_16x16x32_bf16 v[100:103], a[20:23], v[52:55], v[100:103]
v_max3_f32 v112, v112, v70, v71
v_max_f32 v112, v112, v116
v_mfma_f32_16x16x32_bf16 v[104:107], a[36:39], v[52:55], v[104:107]
v_mov_b32 v116, v112
s_nop 1
v_permlane16_swap_b32 v116, v112
v_mfma_f32_16x16x32_bf16 v[108:111], a[52:55], v[52:55], v[108:111]
v_max_f32 v112, v112, v116
v_mov_b32 v116, v112
s_waitcnt lgkmcnt(1)
v_mfma_f32_16x16x32_bf16 v[96:99], a[8:11], v[56:59], v[96:99]
v_permlane32_swap_b32 v116, v112
v_max_f32 v112, v112, v116
v_mfma_f32_16x16x32_bf16 v[100:103], a[24:27], v[56:59], v[100:103]
v_mul_f32 v112, v112, v127
v_pk_fma_f32 v[64:65], v[64:65], v[126:127], v[112:113] op_sel:[0,1,0] op_sel_hi:[1,1,0] neg_lo:[0,0,1] neg_hi:[0,0,1]
v_mfma_f32_16x16x32_bf16 v[104:107], a[40:43], v[56:59], v[104:107]
v_pk_fma_f32 v[66:67], v[66:67], v[126:127], v[112:113] op_sel:[0,1,0] op_sel_hi:[1,1,0] neg_lo:[0,0,1] neg_hi:[0,0,1]
v_pk_fma_f32 v[68:69], v[68:69], v[126:127], v[112:113] op_sel:[0,1,0] op_sel_hi:[1,1,0] neg_lo:[0,0,1] neg_hi:[0,0,1]
v_mfma_f32_16x16x32_bf16 v[108:111], a[56:59], v[56:59], v[108:111]
v_pk_fma_f32 v[70:71], v[70:71], v[126:127], v[112:113] op_sel:[0,1,0] op_sel_hi:[1,1,0] neg_lo:[0,0,1] neg_hi:[0,0,1]
v_exp_f32_dpp v64, v64 quad_perm:[0,0,2,2] row_mask:0xf bank_mask:0xf
s_waitcnt lgkmcnt(0)
v_mfma_f32_16x16x32_bf16 v[96:99], a[12:15], v[60:63], v[96:99]
v_exp_f32_dpp v65, v65 quad_perm:[0,0,2,2] row_mask:0xf bank_mask:0xf
v_exp_f32_dpp v66, v66 quad_perm:[0,0,2,2] row_mask:0xf bank_mask:0xf
v_mfma_f32_16x16x32_bf16 v[100:103], a[28:31], v[60:63], v[100:103]
v_exp_f32_dpp v67, v67 quad_perm:[0,0,2,2] row_mask:0xf bank_mask:0xf
v_exp_f32_dpp v68, v68 quad_perm:[0,0,2,2] row_mask:0xf bank_mask:0xf
v_mfma_f32_16x16x32_bf16 v[104:107], a[44:47], v[60:63], v[104:107]
v_exp_f32_dpp v69, v69 quad_perm:[0,0,2,2] row_mask:0xf bank_mask:0xf
v_exp_f32_dpp v70, v70 quad_perm:[0,0,2,2] row_mask:0xf bank_mask:0xf
v_mfma_f32_16x16x32_bf16 v[108:111], a[60:63], v[60:63], v[108:111]
v_exp_f32_dpp v71, v71 quad_perm:[0,0,2,2] row_mask:0xf bank_mask:0xf
v_mov_b64 v[92:93], 0
v_mov_b64 v[94:95], 0
v_pk_add_f32 v[118:119], v[64:65], v[66:67]
v_pk_add_f32 v[118:119], v[118:119], v[68:69]
v_pk_add_f32 v[118:119], v[118:119], v[70:71]
v_add_f32 v113, v118, v119
v_add_f32_dpp v72, v97, v96 quad_perm:[1,0,3,2] row_mask:0xf bank_mask:0xf
v_add_f32_dpp v73, v101, v100 quad_perm:[1,0,3,2] row_mask:0xf bank_mask:0xf
v_add_f32_dpp v74, v99, v98 quad_perm:[1,0,3,2] row_mask:0xf bank_mask:0xf
v_add_f32_dpp v75, v103, v102 quad_perm:[1,0,3,2] row_mask:0xf bank_mask:0xf
v_add_f32_dpp v76, v105, v104 quad_perm:[1,0,3,2] row_mask:0xf bank_mask:0xf
v_add_f32_dpp v77, v109, v108 quad_perm:[1,0,3,2] row_mask:0xf bank_mask:0xf
v_add_f32_dpp v78, v107, v106 quad_perm:[1,0,3,2] row_mask:0xf bank_mask:0xf
v_add_f32_dpp v79, v111, v110 quad_perm:[1,0,3,2] row_mask:0xf bank_mask:0xf
v_max3_f32 v114, v72, v73, v74
v_mov_b64 v[96:97], 0
v_max3_f32 v117, v75, v76, v77
v_mov_b64 v[98:99], 0
v_max3_f32 v114, v114, v78, v79
v_mov_b64 v[100:101], 0
v_max_f32 v114, v114, v117
v_mov_b64 v[102:103], 0
v_mov_b32 v117, v114
v_mov_b64 v[104:105], 0
v_mov_b64 v[106:107], 0
v_permlane16_swap_b32 v117, v114
v_max_f32 v114, v114, v117
v_mov_b32 v117, v114
v_mov_b32 v116, v113
v_cvt_pk_bf16_f32 v118, v64, v65
v_permlane32_swap_b32 v117, v114
v_permlane16_swap_b32 v116, v113
v_max_f32 v114, v114, v117
v_add_f32 v113, v113, v116
v_mul_f32 v114, v114, v127
v_mov_b32 v116, v113
v_pk_fma_f32 v[72:73], v[72:73], v[126:127], v[114:115] op_sel:[0,1,0] op_sel_hi:[1,1,0] neg_lo:[0,0,1] neg_hi:[0,0,1]
v_pk_fma_f32 v[74:75], v[74:75], v[126:127], v[114:115] op_sel:[0,1,0] op_sel_hi:[1,1,0] neg_lo:[0,0,1] neg_hi:[0,0,1]
v_permlane32_swap_b32 v116, v113
v_pk_fma_f32 v[76:77], v[76:77], v[126:127], v[114:115] op_sel:[0,1,0] op_sel_hi:[1,1,0] neg_lo:[0,0,1] neg_hi:[0,0,1]
v_add_f32 v113, v113, v116
v_pk_fma_f32 v[78:79], v[78:79], v[126:127], v[114:115] op_sel:[0,1,0] op_sel_hi:[1,1,0] neg_lo:[0,0,1] neg_hi:[0,0,1]
v_exp_f32_dpp v72, v72 quad_perm:[0,0,2,2] row_mask:0xf bank_mask:0xf
v_exp_f32_dpp v73, v73 quad_perm:[0,0,2,2] row_mask:0xf bank_mask:0xf
v_exp_f32_dpp v74, v74 quad_perm:[0,0,2,2] row_mask:0xf bank_mask:0xf
v_exp_f32_dpp v75, v75 quad_perm:[0,0,2,2] row_mask:0xf bank_mask:0xf
v_exp_f32_dpp v76, v76 quad_perm:[0,0,2,2] row_mask:0xf bank_mask:0xf
v_exp_f32_dpp v77, v77 quad_perm:[0,0,2,2] row_mask:0xf bank_mask:0xf
v_exp_f32_dpp v78, v78 quad_perm:[0,0,2,2] row_mask:0xf bank_mask:0xf
v_exp_f32_dpp v79, v79 quad_perm:[0,0,2,2] row_mask:0xf bank_mask:0xf
v_and_b32 v80, v118, v122
v_and_b32 v81, v118, v123
v_and_b32 v82, v118, v124
v_and_b32 v83, v118, v125
v_cvt_pk_bf16_f32 v118, v66, v67
v_and_b32 v84, v118, v122
v_and_b32 v85, v118, v123
v_smfmac_f32_16x16x64_bf16 v[92:95], v[80:83], a[192:199], v126
v_and_b32 v86, v118, v124
v_and_b32 v87, v118, v125
v_pk_add_f32 v[120:121], v[72:73], v[74:75]
v_smfmac_f32_16x16x64_bf16 v[96:99], v[80:83], a[200:207], v126
v_cvt_pk_bf16_f32 v118, v68, v69
v_and_b32 v80, v118, v122
v_and_b32 v81, v118, v123
v_smfmac_f32_16x16x64_bf16 v[92:95], v[84:87], a[208:215], v126
v_and_b32 v82, v118, v124
v_and_b32 v83, v118, v125
v_pk_add_f32 v[120:121], v[120:121], v[76:77]
v_smfmac_f32_16x16x64_bf16 v[96:99], v[84:87], a[216:223], v126
v_cvt_pk_bf16_f32 v118, v70, v71
v_and_b32 v84, v118, v122
v_and_b32 v85, v118, v123
v_smfmac_f32_16x16x64_bf16 v[92:95], v[80:83], a[224:231], v126
v_and_b32 v86, v118, v124
v_and_b32 v87, v118, v125
v_pk_add_f32 v[120:121], v[120:121], v[78:79]
v_smfmac_f32_16x16x64_bf16 v[96:99], v[80:83], a[232:239], v126
v_cvt_pk_bf16_f32 v118, v72, v73
v_and_b32 v80, v118, v122
v_and_b32 v81, v118, v123
v_smfmac_f32_16x16x64_bf16 v[92:95], v[84:87], a[240:247], v126
v_and_b32 v82, v118, v124
v_and_b32 v83, v118, v125
v_add_f32 v115, v120, v121
v_smfmac_f32_16x16x64_bf16 v[96:99], v[84:87], a[248:255], v126
v_cvt_pk_bf16_f32 v118, v74, v75
v_and_b32 v84, v118, v122
v_and_b32 v85, v118, v123
v_smfmac_f32_16x16x64_bf16 v[100:103], v[80:83], a[64:71], v126
v_and_b32 v86, v118, v124
v_and_b32 v87, v118, v125
v_mov_b32 v117, v115
v_smfmac_f32_16x16x64_bf16 v[104:107], v[80:83], a[72:79], v126
v_cvt_pk_bf16_f32 v118, v76, v77
v_and_b32 v80, v118, v122
v_and_b32 v81, v118, v123
v_smfmac_f32_16x16x64_bf16 v[100:103], v[84:87], a[80:87], v126
v_and_b32 v82, v118, v124
v_and_b32 v83, v118, v125
v_smfmac_f32_16x16x64_bf16 v[104:107], v[84:87], a[88:95], v126
v_cvt_pk_bf16_f32 v118, v78, v79
v_and_b32 v84, v118, v122
v_and_b32 v85, v118, v123
v_smfmac_f32_16x16x64_bf16 v[100:103], v[80:83], a[96:103], v126
v_and_b32 v86, v118, v124
v_and_b32 v87, v118, v125
v_permlane16_swap_b32 v117, v115
v_smfmac_f32_16x16x64_bf16 v[104:107], v[80:83], a[104:111], v126
v_add_f32 v115, v115, v117
v_mov_b32 v117, v115
v_smfmac_f32_16x16x64_bf16 v[100:103], v[84:87], a[112:119], v126
s_nop 0
v_permlane32_swap_b32 v117, v115
v_add_f32 v115, v115, v117
v_smfmac_f32_16x16x64_bf16 v[104:107], v[84:87], a[120:127], v126
ds_write_b128 v14, v[92:95] offset:0
ds_write_b128 v14, v[96:99] offset:512
s_mov_b64 exec, 0x101
ds_write_b64 v15, v[112:113]
ds_write_b64 v15, v[114:115] offset:64
s_mov_b64 exec, -1
ds_write_b128 v14, v[100:103] offset:2048
s_nop 0
ds_write_b128 v14, v[104:107] offset:2560
s_waitcnt lgkmcnt(0)
s_barrier
ds_read_b128 v[48:51], v17
ds_read_b128 v[52:55], v17 offset:16
ds_read_b128 v[32:35], v16 offset:0
ds_read_b128 v[36:39], v16 offset:4096
ds_read_b128 v[40:43], v16 offset:8192
ds_read_b128 v[44:47], v16 offset:12288
s_waitcnt lgkmcnt(4)
v_max3_f32 v56, v48, v50, v52
v_max_f32 v56, v56, v54
v_sub_f32 v48, v48, v56
v_sub_f32 v50, v50, v56
v_sub_f32 v52, v52, v56
v_sub_f32 v54, v54, v56
v_exp_f32 v48, v48
v_exp_f32 v50, v50
v_exp_f32 v52, v52
v_exp_f32 v54, v54
v_mul_f32 v57, v48, v49
v_fmac_f32 v57, v50, v51
v_fmac_f32 v57, v52, v53
v_fmac_f32 v57, v54, v55
v_rcp_f32 v58, v57
v_log_f32 v59, v57
s_waitcnt lgkmcnt(0)
v_pk_mul_f32 v[60:61], v[32:33], v[48:49] op_sel_hi:[1,0]
v_pk_mul_f32 v[62:63], v[34:35], v[48:49] op_sel_hi:[1,0]
v_add_f32 v59, v59, v56
v_pk_fma_f32 v[60:61], v[36:37], v[50:51], v[60:61] op_sel_hi:[1,0,1]
v_pk_fma_f32 v[62:63], v[38:39], v[50:51], v[62:63] op_sel_hi:[1,0,1]
v_pk_fma_f32 v[60:61], v[40:41], v[52:53], v[60:61] op_sel_hi:[1,0,1]
v_pk_fma_f32 v[62:63], v[42:43], v[52:53], v[62:63] op_sel_hi:[1,0,1]
v_pk_fma_f32 v[60:61], v[44:45], v[54:55], v[60:61] op_sel_hi:[1,0,1]
v_pk_fma_f32 v[62:63], v[46:47], v[54:55], v[62:63] op_sel_hi:[1,0,1]
v_min_u32 v59, -2, v59
v_pk_mul_f32 v[60:61], v[60:61], v[58:59] op_sel_hi:[1,0]
v_pk_mul_f32 v[62:63], v[62:63], v[58:59] op_sel_hi:[1,0]
v_cvt_pk_bf16_f32 v64, v60, v61
v_cvt_pk_bf16_f32 v65, v62, v63
v_min_u32 v64, -2, v64
v_min_u32 v65, -2, v65
s_cmp_lg_u32 s101, 0
s_cbranch_scc0 L_gs2
buffer_store_dwordx2 v[64:65], v3, s[52:55], s84 offen
s_mov_b64 exec, 1
buffer_store_dword v59, v6, s[52:55], s85 offen
s_mov_b64 exec, -1
L_gsb2:
s_cmp_lg_u32 s23, 0
s_cbranch_scc1 L_q_0
s_mov_b32 s88, 0
L_g1p_0:
buffer_load_dwordx4 v[64:67], v5, s[52:55], s79 offen sc1
buffer_load_dwordx4 v[68:71], v5, s[52:55], s79 offen offset:16 sc1
s_waitcnt vmcnt(0)
v_max3_u32 v79, v64, v65, v66
v_max3_u32 v78, v67, v68, v69
v_max3_u32 v79, v79, v70, v71
v_max_u32 v79, v79, v78
v_cmp_eq_u32 vcc, -1, v79
s_cbranch_vccz L_g1px_0
s_add_u32 s88, s88, 1
s_cmp_lt_u32 s88, 200000
s_cbranch_scc1 L_g1p_0
L_g1px_0:
buffer_load_dwordx4 v[32:35], v4, s[52:55], s81 offen offset:0 sc1
buffer_load_dwordx4 v[36:39], v4, s[52:55], s81 offen offset:1024 sc1
buffer_load_dwordx4 v[40:43], v4, s[52:55], s81 offen offset:2048 sc1
buffer_load_dwordx4 v[44:47], v4, s[52:55], s81 offen offset:3072 sc1
buffer_load_dwordx4 v[48:51], v4, s[52:55], s82 offen offset:0 sc1
buffer_load_dwordx4 v[52:55], v4, s[52:55], s82 offen offset:1024 sc1
buffer_load_dwordx4 v[56:59], v4, s[52:55], s82 offen offset:2048 sc1
buffer_load_dwordx4 v[60:63], v4, s[52:55], s82 offen offset:3072 sc1
v_mov_b32 v76, v122
v_mov_b32 v77, v123
v_mov_b32 v78, v124
v_mov_b32 v90, v125
v_mov_b32 v91, v126
ds_read_b64_tr_b16 v[96:97], v20 offset:0
ds_read_b64_tr_b16 v[98:99], v20 offset:128
ds_read_b64_tr_b16 v[100:101], v20 offset:1024
ds_read_b64_tr_b16 v[102:103], v20 offset:1152
ds_read_b64_tr_b16 v[104:105], v20 offset:2048
ds_read_b64_tr_b16 v[106:107], v20 offset:2176
ds_read_b64_tr_b16 v[108:109], v20 offset:3072
ds_read_b64_tr_b16 v[110:111], v20 offset:3200
ds_read_b64_tr_b16 v[112:113], v20 offset:4096
ds_read_b64_tr_b16 v[114:115], v20 offset:4224
ds_read_b64_tr_b16 v[116:117], v20 offset:5120
ds_read_b64_tr_b16 v[118:119], v20 offset:5248
s_waitcnt lgkmcnt(6)
ds_read_b64_tr_b16 v[120:121], v20 offset:6144
ds_read_b64_tr_b16 v[122:123], v20 offset:6272
ds_read_b64_tr_b16 v[124:125], v20 offset:7168
ds_read_b64_tr_b16 v[126:127], v20 offset:7296
L_g1c_0:
v_max3_f32 v72, v64, v65, v66
v_max3_f32 v73, v67, v68, v69
v_max3_f32 v72, v72, v70, v71
v_max_f32 v72, v72, v73
v_mov_b32 v73, v72
s_nop 1
v_permlane16_swap_b32 v73, v72
v_max_f32 v72, v72, v73
v_mov_b32 v73, v72
s_nop 1
v_permlane32_swap_b32 v73, v72
v_max_f32 v72, v72, v73
v_sub_f32 v64, v64, v72
v_sub_f32 v65, v65, v72
v_sub_f32 v66, v66, v72
v_sub_f32 v67, v67, v72
v_sub_f32 v68, v68, v72
v_sub_f32 v69, v69, v72
v_sub_f32 v70, v70, v72
v_sub_f32 v71, v71, v72
v_exp_f32 v64, v64
v_exp_f32 v65, v65
v_exp_f32 v66, v66
v_exp_f32 v67, v67
v_exp_f32 v68, v68
v_exp_f32 v69, v69
v_exp_f32 v70, v70
v_exp_f32 v71, v71
v_mov_b64 v[92:93], 0
v_mov_b64 v[94:95], 0
v_cvt_pk_bf16_f32 v88, v64, v65
v_cvt_pk_bf16_f32 v89, v66, v67
v_and_b32 v80, v88, v76
v_and_b32 v81, v88, v77
v_and_b32 v82, v88, v78
v_and_b32 v83, v88, v90
v_and_b32 v84, v89, v76
v_and_b32 v85, v89, v77
v_and_b32 v86, v89, v78
v_and_b32 v87, v89, v90
v_add_f32 v74, v64, v65
v_add_f32 v75, v66, v67
s_waitcnt vmcnt(0)
v_smfmac_f32_16x16x64_bf16 v[92:95], v[80:83], v[32:39], v91
v_cvt_pk_bf16_f32 v88, v68, v69
v_and_b32 v80, v88, v76
v_and_b32 v81, v88, v77
v_and_b32 v82, v88, v78
v_and_b32 v83, v88, v90
v_add_f32 v74, v74, v75
v_add_f32 v75, v68, v69
v_smfmac_f32_16x16x64_bf16 v[92:95], v[84:87], v[40:47], v91
v_cvt_pk_bf16_f32 v89, v70, v71
v_and_b32 v84, v89, v76
v_and_b32 v85, v89, v77
v_and_b32 v86, v89, v78
v_and_b32 v87, v89, v90
v_add_f32 v73, v70, v71
v_add_f32 v75, v75, v73
v_smfmac_f32_16x16x64_bf16 v[92:95], v[80:83], v[48:55], v91
v_add_f32 v74, v74, v75
v_mov_b32 v73, v74
s_nop 1
v_permlane16_swap_b32 v73, v74
v_add_f32 v74, v74, v73
v_smfmac_f32_16x16x64_bf16 v[92:95], v[84:87], v[56:63], v91
v_mov_b32 v73, v74
s_nop 1
v_permlane32_swap_b32 v73, v74
v_add_f32 v74, v74, v73
v_rcp_f32 v74, v74
s_nop 1
v_mul_f32 v92, v92, v74
v_mul_f32 v93, v93, v74
v_mul_f32 v94, v94, v74
v_mul_f32 v95, v95, v74
v_add_f32 v72, v92, v93
v_add_f32 v73, v94, v95
v_add_f32 v72, v72, v73
v_cmp_u_f32 vcc, v72, v72
s_cbranch_vccnz L_g1r_0
L_g1ok_0:
s_mov_b32 s89, 0
v_cvt_pk_bf16_f32 v76, v92, v93
v_cvt_pk_bf16_f32 v77, v94, v95
ds_write_b64 v18, v[76:77]
s_waitcnt lgkmcnt(0)
s_barrier
ds_read_b128 v[32:35], v19 offset:0
ds_read_b128 v[36:39], v19 offset:64
ds_read_b128 v[40:43], v19 offset:128
ds_read_b128 v[44:47], v19 offset:192
ds_read_b128 v[48:51], v19 offset:256
ds_read_b128 v[52:55], v19 offset:320
ds_read_b128 v[56:59], v19 offset:384
ds_read_b128 v[60:63], v19 offset:448
s_waitcnt lgkmcnt(7)
v_mfma_f32_16x16x32_bf16 v[92:95], v[96:99], v[32:35], 0
s_waitcnt lgkmcnt(6)
v_mfma_f32_16x16x32_bf16 v[92:95], v[100:103], v[36:39], v[92:95]
s_waitcnt lgkmcnt(5)
v_mfma_f32_16x16x32_bf16 v[92:95], v[104:107], v[40:43], v[92:95]
s_waitcnt lgkmcnt(4)
v_mfma_f32_16x16x32_bf16 v[92:95], v[108:111], v[44:47], v[92:95]
s_waitcnt lgkmcnt(3)
v_mfma_f32_16x16x32_bf16 v[92:95], v[112:115], v[48:51], v[92:95]
s_waitcnt lgkmcnt(2)
v_mfma_f32_16x16x32_bf16 v[92:95], v[116:119], v[52:55], v[92:95]
s_waitcnt lgkmcnt(1)
v_mfma_f32_16x16x32_bf16 v[92:95], v[120:123], v[56:59], v[92:95]
s_waitcnt lgkmcnt(0)
v_mfma_f32_16x16x32_bf16 v[92:95], v[124:127], v[60:63], v[92:95]
s_mov_b32 exec_lo, 0x00030003
s_cmp_eq_u32 s65, 3
s_cselect_b32 exec_hi, 0, 0x00030003
s_nop 4
v_cvt_pk_bf16_f32 v76, v92, v93
v_cvt_pk_bf16_f32 v77, v94, v95
v_min_u32 v76, -2, v76
v_min_u32 v77, -2, v77
buffer_store_dwordx2 v[76:77], v7, s[52:55], s80 offen sc1
s_mov_b64 exec, -1
s_cmp_eq_u32 s65, 0
s_cbranch_scc0 L_nof2_0
v_mov_b32 v78, s14
s_lshl_b32 s90, s66, 2
v_mov_b32 v79, s90
s_mov_b64 exec, 1
buffer_store_dword v78, v79, s[52:55], s17 offen sc1
s_mov_b64 exec, -1
L_nof2_0:
s_barrier
buffer_load_dwordx4 a[156:159], v1, s[44:47], s68 offen offset:896 nt
buffer_load_dwordx4 a[160:163], v1, s[44:47], s69 offen offset:0 nt
buffer_load_dwordx4 a[164:167], v1, s[44:47], s69 offen offset:128 nt
buffer_load_dwordx4 a[168:171], v1, s[44:47], s69 offen offset:256 nt
buffer_load_dwordx4 a[172:175], v1, s[44:47], s69 offen offset:384 nt
buffer_load_dwordx4 a[176:179], v1, s[44:47], s69 offen offset:512 nt
buffer_load_dwordx4 a[180:183], v1, s[44:47], s69 offen offset:640 nt
buffer_load_dwordx4 a[184:187], v1, s[44:47], s69 offen offset:768 nt
buffer_load_dwordx4 a[188:191], v1, s[44:47], s69 offen offset:896 nt
buffer_load_dwordx4 a[192:195], v2, s[48:51], s68 offen offset:0 nt
buffer_load_dwordx4 a[196:199], v2, s[48:51], s68 offen offset:2048 nt
buffer_load_dwordx4 a[200:203], v2, s[48:51], s68 offen offset:256 nt
buffer_load_dwordx4 a[204:207], v2, s[48:51], s68 offen offset:2304 nt
buffer_load_dwordx4 a[208:211], v2, s[48:51], s68 offen offset:1024 nt
buffer_load_dwordx4 a[212:215], v2, s[48:51], s68 offen offset:3072 nt
buffer_load_dwordx4 a[216:219], v2, s[48:51], s68 offen offset:1280 nt
buffer_load_dwordx4 a[220:223], v2, s[48:51], s68 offen offset:3328 nt
buffer_load_dwordx4 a[224:227], v2, s[48:51], s69 offen offset:0 nt
buffer_load_dwordx4 a[228:231], v2, s[48:51], s69 offen offset:2048 nt
buffer_load_dwordx4 a[232:235], v2, s[48:51], s69 offen offset:256 nt
buffer_load_dwordx4 a[236:239], v2, s[48:51], s69 offen offset:2304 nt
buffer_load_dwordx4 a[240:243], v2, s[48:51], s69 offen offset:1024 nt
buffer_load_dwordx4 a[244:247], v2, s[48:51], s69 offen offset:3072 nt
buffer_load_dwordx4 a[248:251], v2, s[48:51], s69 offen offset:1280 nt
buffer_load_dwordx4 a[252:255], v2, s[48:51], s69 offen offset:3328 nt
s_branch L_e_0
L_q_0:
s_barrier
buffer_load_dwordx4 a[156:159], v1, s[44:47], s68 offen offset:896 nt
buffer_load_dwordx4 a[160:163], v1, s[44:47], s69 offen offset:0 nt
buffer_load_dwordx4 a[164:167], v1, s[44:47], s69 offen offset:128 nt
buffer_load_dwordx4 a[168:171], v1, s[44:47], s69 offen offset:256 nt
buffer_load_dwordx4 a[172:175], v1, s[44:47], s69 offen offset:384 nt
buffer_load_dwordx4 a[176:179], v1, s[44:47], s69 offen offset:512 nt
buffer_load_dwordx4 a[180:183], v1, s[44:47], s69 offen offset:640 nt
buffer_load_dwordx4 a[184:187], v1, s[44:47], s69 offen offset:768 nt
buffer_load_dwordx4 a[188:191], v1, s[44:47], s69 offen offset:896 nt
buffer_load_dwordx4 a[192:195], v2, s[48:51], s68 offen offset:0 nt
buffer_load_dwordx4 a[196:199], v2, s[48:51], s68 offen offset:2048 nt
buffer_load_dwordx4 a[200:203], v2, s[48:51], s68 offen offset:256 nt
buffer_load_dwordx4 a[204:207], v2, s[48:51], s68 offen offset:2304 nt
buffer_load_dwordx4 a[208:211], v2, s[48:51], s68 offen offset:1024 nt
buffer_load_dwordx4 a[212:215], v2, s[48:51], s68 offen offset:3072 nt
buffer_load_dwordx4 a[216:219], v2, s[48:51], s68 offen offset:1280 nt
buffer_load_dwordx4 a[220:223], v2, s[48:51], s68 offen offset:3328 nt
buffer_load_dwordx4 a[224:227], v2, s[48:51], s69 offen offset:0 nt
buffer_load_dwordx4 a[228:231], v2, s[48:51], s69 offen offset:2048 nt
s_cmp_lg_u32 s65, 2
s_cbranch_scc1 L_nop2_0
s_mov_b32 s88, 0
L_hp_2_0:
s_load_dwordx8 s[4:11], s[40:41], s17 glc
s_waitcnt lgkmcnt(0)
s_xor_b64 s[4:5], s[4:5], s[14:15]
s_xor_b64 s[6:7], s[6:7], s[14:15]
s_xor_b64 s[8:9], s[8:9], s[14:15]
s_xor_b64 s[10:11], s[10:11], s[14:15]
s_or_b64 s[4:5], s[4:5], s[6:7]
s_or_b64 s[8:9], s[8:9], s[10:11]
s_or_b64 s[4:5], s[4:5], s[8:9]
s_cbranch_scc0 L_hpx_2_0
s_add_u32 s88, s88, 1
s_cmp_lt_u32 s88, 400
s_cbranch_scc1 L_hp_2_0
L_hpx_2_0:
L_nop2_0:
s_barrier
v_subrev_u32 v92, 98304, v23
v_subrev_u32 v93, 98304, v24
buffer_load_dwordx4 v[32:35], v8, s[52:55], s80 offen offset:0
buffer_load_dwordx4 v[36:39], v8, s[52:55], s80 offen offset:1024
buffer_load_dwordx4 v[40:43], v8, s[52:55], s80 offen offset:2048
buffer_load_dwordx4 v[44:47], v8, s[52:55], s80 offen offset:3072
buffer_load_dwordx4 v[48:51], v9, s[52:55], s80 offen offset:0
buffer_load_dwordx4 v[52:55], v9, s[52:55], s80 offen offset:1024
buffer_load_dwordx4 v[56:59], v9, s[52:55], s80 offen offset:2048
buffer_load_dwordx4 v[60:63], v9, s[52:55], s80 offen offset:3072
buffer_load_dwordx2 v[84:85], v92, s[60:63], s24 offen
buffer_load_dwordx2 v[88:89], v93, s[60:63], s24 offen
s_barrier
buffer_load_dwordx4 a[232:235], v2, s[48:51], s69 offen offset:256 nt
buffer_load_dwordx4 a[236:239], v2, s[48:51], s69 offen offset:2304 nt
buffer_load_dwordx4 a[240:243], v2, s[48:51], s69 offen offset:1024 nt
buffer_load_dwordx4 a[244:247], v2, s[48:51], s69 offen offset:3072 nt
buffer_load_dwordx4 a[248:251], v2, s[48:51], s69 offen offset:1280 nt
buffer_load_dwordx4 a[252:255], v2, s[48:51], s69 offen offset:3328 nt
v_mov_b32 v94, 0x3f803f80
v_and_b32 v80, v94, v122
v_and_b32 v81, v94, v123
v_and_b32 v82, v94, v124
v_and_b32 v83, v94, v125
v_mov_b32 v90, v126
v_subrev_u32 v76, 98304, v23
v_subrev_u32 v76, s71, v76
v_subrev_u32 v77, 98304, v24
v_subrev_u32 v77, s71, v77
v_min_u32 v78, 0x378, v76
v_add_u32 v78, s72, v78
v_min_u32 v79, 0x378, v77
v_add_u32 v79, s72, v79
ds_read_b64 v[72:73], v78
ds_read_b64 v[74:75], v79
s_cmp_gt_u32 s65, 1
s_cbranch_scc1 L_nowq_0
ds_read_b64_tr_b16 v[96:97], v21 offset:0
ds_read_b64_tr_b16 v[98:99], v21 offset:128
ds_read_b64_tr_b16 v[100:101], v21 offset:1024
ds_read_b64_tr_b16 v[102:103], v21 offset:1152
ds_read_b64_tr_b16 v[104:105], v21 offset:2048
ds_read_b64_tr_b16 v[106:107], v21 offset:2176
ds_read_b64_tr_b16 v[108:109], v21 offset:3072
ds_read_b64_tr_b16 v[110:111], v21 offset:3200
ds_read_b64_tr_b16 v[112:113], v21 offset:4096
ds_read_b64_tr_b16 v[114:115], v21 offset:4224
ds_read_b64_tr_b16 v[116:117], v21 offset:5120
ds_read_b64_tr_b16 v[118:119], v21 offset:5248
s_waitcnt lgkmcnt(6)
ds_read_b64_tr_b16 v[120:121], v21 offset:6144
ds_read_b64_tr_b16 v[122:123], v21 offset:6272
ds_read_b64_tr_b16 v[124:125], v21 offset:7168
ds_read_b64_tr_b16 v[126:127], v21 offset:7296
L_nowq_0:
s_waitcnt vmcnt(6)
L_g2c_0:
v_lshlrev_b32 v64, 16, v84
v_and_b32 v65, 0xffff0000, v84
v_lshlrev_b32 v66, 16, v85
v_and_b32 v67, 0xffff0000, v85
v_lshlrev_b32 v68, 16, v88
v_and_b32 v69, 0xffff0000, v88
v_lshlrev_b32 v70, 16, v89
v_and_b32 v71, 0xffff0000, v89
v_smfmac_f32_16x16x64_bf16 v[64:67], v[80:83], v[32:39], v90
s_nop 0
v_smfmac_f32_16x16x64_bf16 v[68:71], v[80:83], v[48:55], v90
v_smfmac_f32_16x16x64_bf16 v[64:67], v[80:83], v[40:47], v90
v_smfmac_f32_16x16x64_bf16 v[68:71], v[80:83], v[56:63], v90
s_nop 6
v_add_f32 v92, v64, v65
v_add_f32 v93, v66, v67
v_add_f32 v94, v68, v69
v_add_f32 v95, v70, v71
v_add_f32 v92, v92, v93
v_add_f32 v94, v94, v95
v_add_f32 v92, v92, v94
v_cmp_u_f32 vcc, v92, v92
s_cbranch_vccnz L_g2r_0
L_g2ok_0:
s_mov_b32 s89, 0
v_cvt_pk_bf16_f32 v64, v64, v65
v_cvt_pk_bf16_f32 v65, v66, v67
v_cvt_pk_bf16_f32 v66, v68, v69
v_cvt_pk_bf16_f32 v67, v70, v71
s_waitcnt lgkmcnt(0)
s_cmp_eq_u32 s70, 0
s_cbranch_scc1 L_xw_0
s_movk_i32 s90, 896
v_cmp_gt_u32 vcc, s90, v76
s_cmp_eq_u32 s74, 0
s_cselect_b32 s91, 1, 0
s_cmp_ge_u32 s64, 2
s_cselect_b32 s91, s91, 0
s_cmp_eq_u32 s91, 0
s_cbranch_scc1 L_noout_0
s_and_b64 s[92:93], vcc, exec
s_mov_b32 s93, 0
s_mov_b64 exec, s[92:93]
buffer_store_dwordx2 v[64:65], v76, s[56:59], s73 offen
s_mov_b64 exec, -1
s_movk_i32 s90, 896
v_cmp_gt_u32 s[92:93], s90, v77
s_mov_b32 s93, 0
s_mov_b64 exec, s[92:93]
buffer_store_dwordx2 v[66:67], v77, s[56:59], s73 offen
s_mov_b64 exec, -1
L_noout_0:
s_movk_i32 s90, 896
v_cmp_gt_u32 vcc, s90, v76
s_nop 1
v_cndmask_b32 v64, v64, v72, vcc
v_cndmask_b32 v65, v65, v73, vcc
v_cmp_gt_u32 vcc, s90, v77
s_nop 1
v_cndmask_b32 v66, v66, v74, vcc
v_cndmask_b32 v67, v67, v75, vcc
L_xw_0:
ds_write_b64 v23, v[64:65]
ds_write_b64 v24, v[66:67]
s_cmp_lg_u32 s66, 0
s_cbranch_scc1 L_noxs_0
s_cmp_lg_u32 s27, 0
s_cbranch_scc1 L_noxs_0
v_min_u32 v68, -2, v64
v_min_u32 v69, -2, v65
v_min_u32 v70, -2, v66
v_min_u32 v71, -2, v67
v_subrev_u32 v92, 98304, v23
v_subrev_u32 v93, 98304, v24
s_mov_b32 exec_hi, 0
buffer_store_dwordx2 v[68:69], v92, s[52:55], s25 offen sc1
buffer_store_dwordx2 v[70:71], v93, s[52:55], s25 offen sc1
s_mov_b32 exec_hi, -1
L_noxs_0:
s_cmp_eq_u32 s64, 17
s_cbranch_scc1 L_e_0
L_qp_0:
s_mov_b32 s76, 61440
s_mov_b32 s42, 77824
s_waitcnt lgkmcnt(0)
s_barrier
s_cmp_gt_u32 s65, 1
s_cbranch_scc1 L_e_0
ds_read_b128 v[32:35], v22 offset:0
ds_read_b128 v[36:39], v22 offset:64
ds_read_b128 v[40:43], v22 offset:128
ds_read_b128 v[44:47], v22 offset:192
ds_read_b128 v[48:51], v22 offset:256
ds_read_b128 v[52:55], v22 offset:320
ds_read_b128 v[56:59], v22 offset:384
ds_read_b128 v[60:63], v22 offset:448
ds_read_b128 v[64:67], v22 offset:512
ds_read_b128 v[68:71], v22 offset:576
ds_read_b128 v[72:75], v22 offset:640
ds_read_b128 v[76:79], v22 offset:704
ds_read_b128 v[80:83], v22 offset:768
ds_read_b128 v[84:87], v22 offset:832
s_waitcnt lgkmcnt(7)
v_mfma_f32_16x16x32_bf16 v[92:95], v[96:99], v[32:35], 0
v_mfma_f32_16x16x32_bf16 v[88:91], v[32:35], v[32:35], 0
ds_read_b64_tr_b16 v[96:97], v21 offset:8192
ds_read_b64_tr_b16 v[98:99], v21 offset:8320
v_mfma_f32_16x16x32_bf16 v[92:95], v[100:103], v[36:39], v[92:95]
v_mfma_f32_16x16x32_bf16 v[88:91], v[36:39], v[36:39], v[88:91]
ds_read_b64_tr_b16 v[100:101], v21 offset:9216
ds_read_b64_tr_b16 v[102:103], v21 offset:9344
v_mfma_f32_16x16x32_bf16 v[92:95], v[104:107], v[40:43], v[92:95]
v_mfma_f32_16x16x32_bf16 v[88:91], v[40:43], v[40:43], v[88:91]
ds_read_b64_tr_b16 v[104:105], v21 offset:10240
ds_read_b64_tr_b16 v[106:107], v21 offset:10368
v_mfma_f32_16x16x32_bf16 v[92:95], v[108:111], v[44:47], v[92:95]
v_mfma_f32_16x16x32_bf16 v[88:91], v[44:47], v[44:47], v[88:91]
ds_read_b64_tr_b16 v[108:109], v21 offset:11264
ds_read_b64_tr_b16 v[110:111], v21 offset:11392
s_waitcnt lgkmcnt(8)
v_mfma_f32_16x16x32_bf16 v[92:95], v[112:115], v[48:51], v[92:95]
v_mfma_f32_16x16x32_bf16 v[88:91], v[48:51], v[48:51], v[88:91]
ds_read_b64_tr_b16 v[112:113], v21 offset:12288
ds_read_b64_tr_b16 v[114:115], v21 offset:12416
v_mfma_f32_16x16x32_bf16 v[92:95], v[116:119], v[52:55], v[92:95]
v_mfma_f32_16x16x32_bf16 v[88:91], v[52:55], v[52:55], v[88:91]
ds_read_b64_tr_b16 v[116:117], v21 offset:13312
ds_read_b64_tr_b16 v[118:119], v21 offset:13440
v_mfma_f32_16x16x32_bf16 v[92:95], v[120:123], v[56:59], v[92:95]
v_mfma_f32_16x16x32_bf16 v[88:91], v[56:59], v[56:59], v[88:91]
v_mfma_f32_16x16x32_bf16 v[92:95], v[124:127], v[60:63], v[92:95]
v_mfma_f32_16x16x32_bf16 v[88:91], v[60:63], v[60:63], v[88:91]
s_waitcnt lgkmcnt(10)
v_mfma_f32_16x16x32_bf16 v[92:95], v[96:99], v[64:67], v[92:95]
v_mfma_f32_16x16x32_bf16 v[88:91], v[64:67], v[64:67], v[88:91]
s_waitcnt lgkmcnt(8)
v_mfma_f32_16x16x32_bf16 v[92:95], v[100:103], v[68:71], v[92:95]
v_mfma_f32_16x16x32_bf16 v[88:91], v[68:71], v[68:71], v[88:91]
s_waitcnt lgkmcnt(6)
v_mfma_f32_16x16x32_bf16 v[92:95], v[104:107], v[72:75], v[92:95]
v_mfma_f32_16x16x32_bf16 v[88:91], v[72:75], v[72:75], v[88:91]
s_waitcnt lgkmcnt(4)
v_mfma_f32_16x16x32_bf16 v[92:95], v[108:111], v[76:79], v[92:95]
v_mfma_f32_16x16x32_bf16 v[88:91], v[76:79], v[76:79], v[88:91]
s_waitcnt lgkmcnt(2)
v_mfma_f32_16x16x32_bf16 v[92:95], v[112:115], v[80:83], v[92:95]
v_mfma_f32_16x16x32_bf16 v[88:91], v[80:83], v[80:83], v[88:91]
s_waitcnt lgkmcnt(0)
v_mfma_f32_16x16x32_bf16 v[92:95], v[116:119], v[84:87], v[92:95]
v_mfma_f32_16x16x32_bf16 v[88:91], v[84:87], v[84:87], v[88:91]
v_and_b32 v32, 1, v0
v_cmp_eq_u32 vcc, 1, v32
v_mov_b32 v34, 0x3b124925
s_nop 4
v_cndmask_b32 v33, v88, v89, vcc
v_mul_f32 v35, v90, v34
v_mul_f32 v33, v33, v34
v_fma_f32 v33, -v35, v35, v33
v_max_f32 v33, 0, v33
v_add_f32 v33, 0x3727c5ac, v33
v_rsq_f32 v33, v33
v_sub_f32 v35, 0, v35
s_nop 1
v_fmac_f32_dpp v92, v92, v35 row_shl:2 row_mask:0xf bank_mask:0xf
v_fmac_f32_dpp v93, v93, v35 row_shl:2 row_mask:0xf bank_mask:0xf
v_fmac_f32_dpp v94, v94, v35 row_shl:2 row_mask:0xf bank_mask:0xf
v_fmac_f32_dpp v95, v95, v35 row_shl:2 row_mask:0xf bank_mask:0xf
v_mul_f32 v92, v92, v33
v_mul_f32 v93, v93, v33
v_mul_f32 v94, v94, v33
v_mul_f32 v95, v95, v33
v_mov_b32 v40, -1
v_mov_b32 v41, -1
v_cvt_pk_bf16_f32 v36, v92, v93
v_cvt_pk_bf16_f32 v37, v94, v95
v_min_u32 v36, -2, v36
v_min_u32 v37, -2, v37
s_mov_b32 exec_lo, 0x00030003
s_mov_b32 exec_hi, 0x00030003
s_cmp_lg_u32 s101, 0
s_cbranch_scc0 L_gs3
buffer_store_dwordx2 v[36:37], v10, s[52:55], s76 offen
buffer_store_dwordx2 v[40:41], v10, s[52:55], s42 offen
L_gsb3:
s_mov_b64 exec, -1
L_e_0:
s_add_u32 s64, s64, 1
s_cmp_eq_u32 s64, 0
s_cbranch_scc1 L_top0
s_add_u32 s14, s14, 0x01010101
s_mov_b32 s15, s14
s_mov_b32 s60, s40
s_mov_b32 s61, s41
s_mov_b32 s62, 67108864
s_lshl_b32 s91, s64, 11
s_add_u32 s24, s91, 622592
s_cmp_ge_u32 s64, 18
s_cbranch_scc1 L_end
L_top1:
s_lshr_b32 s91, s64, 1
s_and_b32 s91, s91, 1
s_lshl_b32 s91, s91, 13
s_add_u32 s78, s91, 61440
s_xor_b32 s91, s91, 8192
s_add_u32 s77, s91, 61440
s_mov_b32 s88, 0
buffer_load_dwordx4 v[112:115], v11, s[52:55], s77 offen sc1
buffer_load_dwordx4 v[116:119], v11, s[52:55], s78 offen sc1
s_xor_b32 s91, s64, s26
s_and_b32 s23, s91, 1
s_add_u32 s90, s64, 1
s_lshr_b32 s91, s90, 1
s_lshl_b32 s68, s91, 24
s_add_u32 s69, s68, 8192
s_cmp_lt_u32 s90, 16
s_cselect_b32 s92, 0x08000000, 0
s_mov_b32 s46, s92
s_mov_b32 s50, s92
s_cselect_b32 s68, s68, 0
s_cselect_b32 s69, s69, 0
s_bitcmp1_b32 s90, 0
s_cselect_b32 s44, s28, s18
s_cselect_b32 s45, s29, s19
s_cselect_b32 s48, s30, s20
s_cselect_b32 s49, s31, s21
s_mov_b32 s79, 98304
s_mul_i32 s91, s64, 28672
s_add_u32 s80, s91, 106496
s_mov_b32 s81, 1185792
s_mov_b32 s82, 1189888
s_lshr_b32 s92, s65, 1
s_lshl_b32 s91, s92, 15
s_add_u32 s83, s91, 1710080
s_lshl_b32 s91, s92, 8
s_add_u32 s43, s91, 102400
s_lshr_b32 s86, s64, 1
s_and_b32 s86, s86, 1
s_xor_b32 s93, s86, s92
s_xor_b32 s93, s93, 1
s_lshl_b32 s91, s93, 15
s_add_u32 s84, s81, s91
s_lshl_b32 s91, s93, 8
s_add_u32 s85, s79, s91
s_and_b32 s70, s64, 1
s_xor_b32 s91, s86, 1
s_mul_i32 s71, s91, 896
s_lshr_b32 s91, s64, 1
s_add_u32 s93, s91, 1
s_min_u32 s93, s93, 7
s_mul_i32 s72, s93, 896
s_add_u32 s72, s72, 90112
s_sub_u32 s73, s91, 1
s_mul_i32 s73, s73, 896
s_lshl_b32 s91, s64, 11
s_add_u32 s25, s91, 624640
v_and_b32 v126, 4, v0
v_cmp_eq_u32 vcc, 0, v126
v_mov_b32 v125, 0xffff
s_nop 0
v_cndmask_b32 v122, 0, v125, vcc
v_xor_b32 v123, v122, v125
v_lshlrev_b32 v124, 16, v122
v_lshlrev_b32 v125, 16, v123
v_and_b32 v126, 3, v0
v_mul_u32_u24 v126, 0x5555, v126
v_mov_b32 v120, -1
v_mov_b32 v121, -1
s_cmp_lg_u32 s101, 0
s_cbranch_scc0 L_gs4
buffer_store_dwordx2 v[120:121], v3, s[52:55], s83 offen
s_mov_b64 exec, 1
buffer_store_dword v120, v6, s[52:55], s43 offen
s_mov_b64 exec, -1
L_gsb4:
s_waitcnt vmcnt(2)
v_max3_u32 v120, v112, v113, v114
v_max3_u32 v121, v115, v116, v117
v_max3_u32 v120, v120, v118, v119
v_max_u32 v120, v120, v121
v_cmp_eq_u32 vcc, -1, v120
s_cbranch_vccz L_g3px_1
L_g3p_1:
buffer_load_dwordx4 v[112:115], v11, s[52:55], s77 offen sc1
buffer_load_dwordx4 v[116:119], v11, s[52:55], s78 offen sc1
s_waitcnt vmcnt(0)
v_max3_u32 v120, v112, v113, v114
v_max3_u32 v121, v115, v116, v117
v_max3_u32 v120, v120, v118, v119
v_max_u32 v120, v120, v121
v_cmp_eq_u32 vcc, -1, v120
s_cbranch_vccz L_g3px_1
s_add_u32 s88, s88, 1
s_cmp_lt_u32 s88, 200000
s_cbranch_scc1 L_g3p_1
L_g3px_1:
ds_write_b128 v12, v[112:115]
ds_write_b128 v12, v[116:119] offset:1024
ds_read_b128 v[32:35], v13 offset:0
ds_read_b128 v[36:39], v13 offset:128
ds_read_b128 v[40:43], v13 offset:256
ds_read_b128 v[44:47], v13 offset:384
ds_read_b128 v[48:51], v13 offset:1024
ds_read_b128 v[52:55], v13 offset:1152
ds_read_b128 v[56:59], v13 offset:1280
ds_read_b128 v[60:63], v13 offset:1408
v_mov_b32 v127, 0x3db8aa3b
s_cmp_ge_u32 s64, 16
s_cbranch_scc1 L_oo_1
s_waitcnt lgkmcnt(7)
v_mfma_f32_16x16x32_bf16 v[80:83], v[128:131], v[32:35], 0
v_mfma_f32_16x16x32_bf16 v[84:87], v[144:147], v[32:35], 0
s_waitcnt lgkmcnt(6)
v_mfma_f32_16x16x32_bf16 v[80:83], v[132:135], v[36:39], v[80:83]
v_mfma_f32_16x16x32_bf16 v[84:87], v[148:151], v[36:39], v[84:87]
s_waitcnt lgkmcnt(5)
v_mfma_f32_16x16x32_bf16 v[80:83], v[136:139], v[40:43], v[80:83]
v_mfma_f32_16x16x32_bf16 v[84:87], v[152:155], v[40:43], v[84:87]
s_waitcnt lgkmcnt(4)
v_mfma_f32_16x16x32_bf16 v[80:83], v[140:143], v[44:47], v[80:83]
v_mfma_f32_16x16x32_bf16 v[84:87], v[156:159], v[44:47], v[84:87]
v_mfma_f32_16x16x32_bf16 v[88:91], v[160:163], v[32:35], 0
buffer_load_dwordx4 v[128:131], v1, s[44:47], s68 offen offset:0 nt
v_mfma_f32_16x16x32_bf16 v[92:95], v[176:179], v[32:35], 0
buffer_load_dwordx4 v[132:135], v1, s[44:47], s68 offen offset:128 nt
v_mfma_f32_16x16x32_bf16 v[88:91], v[164:167], v[36:39], v[88:91]
buffer_load_dwordx4 v[136:139], v1, s[44:47], s68 offen offset:256 nt
v_mfma_f32_16x16x32_bf16 v[92:95], v[180:183], v[36:39], v[92:95]
buffer_load_dwordx4 v[140:143], v1, s[44:47], s68 offen offset:384 nt
v_mfma_f32_16x16x32_bf16 v[88:91], v[168:171], v[40:43], v[88:91]
buffer_load_dwordx4 v[144:147], v1, s[44:47], s68 offen offset:512 nt
v_mfma_f32_16x16x32_bf16 v[92:95], v[184:187], v[40:43], v[92:95]
buffer_load_dwordx4 v[148:151], v1, s[44:47], s68 offen offset:640 nt
v_mfma_f32_16x16x32_bf16 v[88:91], v[172:175], v[44:47], v[88:91]
buffer_load_dwordx4 v[152:155], v1, s[44:47], s68 offen offset:768 nt
v_mfma_f32_16x16x32_bf16 v[92:95], v[188:191], v[44:47], v[92:95]
s_waitcnt lgkmcnt(3)
v_mfma_f32_16x16x32_bf16 v[96:99], a[128:131], v[48:51], 0
v_add_f32_dpp v64, v81, v80 quad_perm:[1,0,3,2] row_mask:0xf bank_mask:0xf
v_add_f32_dpp v65, v85, v84 quad_perm:[1,0,3,2] row_mask:0xf bank_mask:0xf
v_mfma_f32_16x16x32_bf16 v[100:103], a[144:147], v[48:51], 0
v_add_f32_dpp v66, v83, v82 quad_perm:[1,0,3,2] row_mask:0xf bank_mask:0xf
v_add_f32_dpp v67, v87, v86 quad_perm:[1,0,3,2] row_mask:0xf bank_mask:0xf
v_mfma_f32_16x16x32_bf16 v[104:107], a[160:163], v[48:51], 0
v_add_f32_dpp v68, v89, v88 quad_perm:[1,0,3,2] row_mask:0xf bank_mask:0xf
v_add_f32_dpp v69, v93, v92 quad_perm:[1,0,3,2] row_mask:0xf bank_mask:0xf
v_mfma_f32_16x16x32_bf16 v[108:111], a[176:179], v[48:51], 0
v_add_f32_dpp v70, v91, v90 quad_perm:[1,0,3,2] row_mask:0xf bank_mask:0xf
v_add_f32_dpp v71, v95, v94 quad_perm:[1,0,3,2] row_mask:0xf bank_mask:0xf
s_waitcnt lgkmcnt(2)
v_mfma_f32_16x16x32_bf16 v[96:99], a[132:135], v[52:55], v[96:99]
v_max3_f32 v112, v64, v65, v66
v_max3_f32 v116, v67, v68, v69
v_mfma_f32_16x16x32_bf16 v[100:103], a[148:151], v[52:55], v[100:103]
v_max3_f32 v112, v112, v70, v71
v_max_f32 v112, v112, v116
v_mfma_f32_16x16x32_bf16 v[104:107], a[164:167], v[52:55], v[104:107]
v_mov_b32 v116, v112
s_nop 1
v_permlane16_swap_b32 v116, v112
v_mfma_f32_16x16x32_bf16 v[108:111], a[180:183], v[52:55], v[108:111]
v_max_f32 v112, v112, v116
v_mov_b32 v116, v112
s_waitcnt lgkmcnt(1)
v_mfma_f32_16x16x32_bf16 v[96:99], a[136:139], v[56:59], v[96:99]
v_permlane32_swap_b32 v116, v112
v_max_f32 v112, v112, v116
v_mfma_f32_16x16x32_bf16 v[100:103], a[152:155], v[56:59], v[100:103]
v_mul_f32 v112, v112, v127
v_pk_fma_f32 v[64:65], v[64:65], v[126:127], v[112:113] op_sel:[0,1,0] op_sel_hi:[1,1,0] neg_lo:[0,0,1] neg_hi:[0,0,1]
v_mfma_f32_16x16x32_bf16 v[104:107], a[168:171], v[56:59], v[104:107]
v_pk_fma_f32 v[66:67], v[66:67], v[126:127], v[112:113] op_sel:[0,1,0] op_sel_hi:[1,1,0] neg_lo:[0,0,1] neg_hi:[0,0,1]
v_pk_fma_f32 v[68:69], v[68:69], v[126:127], v[112:113] op_sel:[0,1,0] op_sel_hi:[1,1,0] neg_lo:[0,0,1] neg_hi:[0,0,1]
v_mfma_f32_16x16x32_bf16 v[108:111], a[184:187], v[56:59], v[108:111]
v_pk_fma_f32 v[70:71], v[70:71], v[126:127], v[112:113] op_sel:[0,1,0] op_sel_hi:[1,1,0] neg_lo:[0,0,1] neg_hi:[0,0,1]
v_exp_f32_dpp v64, v64 quad_perm:[0,0,2,2] row_mask:0xf bank_mask:0xf
s_waitcnt lgkmcnt(0)
v_mfma_f32_16x16x32_bf16 v[96:99], a[140:143], v[60:63], v[96:99]
v_exp_f32_dpp v65, v65 quad_perm:[0,0,2,2] row_mask:0xf bank_mask:0xf
v_exp_f32_dpp v66, v66 quad_perm:[0,0,2,2] row_mask:0xf bank_mask:0xf
v_mfma_f32_16x16x32_bf16 v[100:103], a[156:159], v[60:63], v[100:103]
v_exp_f32_dpp v67, v67 quad_perm:[0,0,2,2] row_mask:0xf bank_mask:0xf
v_exp_f32_dpp v68, v68 quad_perm:[0,0,2,2] row_mask:0xf bank_mask:0xf
v_mfma_f32_16x16x32_bf16 v[104:107], a[172:175], v[60:63], v[104:107]
v_exp_f32_dpp v69, v69 quad_perm:[0,0,2,2] row_mask:0xf bank_mask:0xf
v_exp_f32_dpp v70, v70 quad_perm:[0,0,2,2] row_mask:0xf bank_mask:0xf
v_mfma_f32_16x16x32_bf16 v[108:111], a[188:191], v[60:63], v[108:111]
v_exp_f32_dpp v71, v71 quad_perm:[0,0,2,2] row_mask:0xf bank_mask:0xf
v_mov_b64 v[92:93], 0
v_mov_b64 v[94:95], 0
v_pk_add_f32 v[118:119], v[64:65], v[66:67]
v_pk_add_f32 v[118:119], v[118:119], v[68:69]
v_pk_add_f32 v[118:119], v[118:119], v[70:71]
v_add_f32 v113, v118, v119
v_add_f32_dpp v72, v97, v96 quad_perm:[1,0,3,2] row_mask:0xf bank_mask:0xf
v_add_f32_dpp v73, v101, v100 quad_perm:[1,0,3,2] row_mask:0xf bank_mask:0xf
v_add_f32_dpp v74, v99, v98 quad_perm:[1,0,3,2] row_mask:0xf bank_mask:0xf
v_add_f32_dpp v75, v103, v102 quad_perm:[1,0,3,2] row_mask:0xf bank_mask:0xf
v_add_f32_dpp v76, v105, v104 quad_perm:[1,0,3,2] row_mask:0xf bank_mask:0xf
v_add_f32_dpp v77, v109, v108 quad_perm:[1,0,3,2] row_mask:0xf bank_mask:0xf
v_add_f32_dpp v78, v107, v106 quad_perm:[1,0,3,2] row_mask:0xf bank_mask:0xf
v_add_f32_dpp v79, v111, v110 quad_perm:[1,0,3,2] row_mask:0xf bank_mask:0xf
v_max3_f32 v114, v72, v73, v74
v_mov_b64 v[96:97], 0
v_max3_f32 v117, v75, v76, v77
v_mov_b64 v[98:99], 0
v_max3_f32 v114, v114, v78, v79
v_mov_b64 v[100:101], 0
v_max_f32 v114, v114, v117
v_mov_b64 v[102:103], 0
v_mov_b32 v117, v114
v_mov_b64 v[104:105], 0
v_mov_b64 v[106:107], 0
v_permlane16_swap_b32 v117, v114
v_max_f32 v114, v114, v117
v_mov_b32 v117, v114
v_mov_b32 v116, v113
v_cvt_pk_bf16_f32 v118, v64, v65
v_permlane32_swap_b32 v117, v114
v_permlane16_swap_b32 v116, v113
v_max_f32 v114, v114, v117
v_add_f32 v113, v113, v116
v_mul_f32 v114, v114, v127
v_mov_b32 v116, v113
v_pk_fma_f32 v[72:73], v[72:73], v[126:127], v[114:115] op_sel:[0,1,0] op_sel_hi:[1,1,0] neg_lo:[0,0,1] neg_hi:[0,0,1]
v_pk_fma_f32 v[74:75], v[74:75], v[126:127], v[114:115] op_sel:[0,1,0] op_sel_hi:[1,1,0] neg_lo:[0,0,1] neg_hi:[0,0,1]
v_permlane32_swap_b32 v116, v113
v_pk_fma_f32 v[76:77], v[76:77], v[126:127], v[114:115] op_sel:[0,1,0] op_sel_hi:[1,1,0] neg_lo:[0,0,1] neg_hi:[0,0,1]
v_add_f32 v113, v113, v116
v_pk_fma_f32 v[78:79], v[78:79], v[126:127], v[114:115] op_sel:[0,1,0] op_sel_hi:[1,1,0] neg_lo:[0,0,1] neg_hi:[0,0,1]
v_exp_f32_dpp v72, v72 quad_perm:[0,0,2,2] row_mask:0xf bank_mask:0xf
v_exp_f32_dpp v73, v73 quad_perm:[0,0,2,2] row_mask:0xf bank_mask:0xf
v_exp_f32_dpp v74, v74 quad_perm:[0,0,2,2] row_mask:0xf bank_mask:0xf
v_exp_f32_dpp v75, v75 quad_perm:[0,0,2,2] row_mask:0xf bank_mask:0xf
v_exp_f32_dpp v76, v76 quad_perm:[0,0,2,2] row_mask:0xf bank_mask:0xf
v_exp_f32_dpp v77, v77 quad_perm:[0,0,2,2] row_mask:0xf bank_mask:0xf
v_exp_f32_dpp v78, v78 quad_perm:[0,0,2,2] row_mask:0xf bank_mask:0xf
v_exp_f32_dpp v79, v79 quad_perm:[0,0,2,2] row_mask:0xf bank_mask:0xf
v_and_b32 v80, v118, v122
v_and_b32 v81, v118, v123
v_and_b32 v82, v118, v124
v_and_b32 v83, v118, v125
v_cvt_pk_bf16_f32 v118, v66, v67
v_and_b32 v84, v118, v122
v_and_b32 v85, v118, v123
v_smfmac_f32_16x16x64_bf16 v[92:95], v[80:83], v[192:199], v126
v_and_b32 v86, v118, v124
v_and_b32 v87, v118, v125
v_pk_add_f32 v[120:121], v[72:73], v[74:75]
v_smfmac_f32_16x16x64_bf16 v[96:99], v[80:83], v[200:207], v126
v_cvt_pk_bf16_f32 v118, v68, v69
v_and_b32 v80, v118, v122
v_and_b32 v81, v118, v123
v_smfmac_f32_16x16x64_bf16 v[92:95], v[84:87], v[208:215], v126
v_and_b32 v82, v118, v124
v_and_b32 v83, v118, v125
v_pk_add_f32 v[120:121], v[120:121], v[76:77]
v_smfmac_f32_16x16x64_bf16 v[96:99], v[84:87], v[216:223], v126
v_cvt_pk_bf16_f32 v118, v70, v71
v_and_b32 v84, v118, v122
v_and_b32 v85, v118, v123
v_smfmac_f32_16x16x64_bf16 v[92:95], v[80:83], v[224:231], v126
v_and_b32 v86, v118, v124
v_and_b32 v87, v118, v125
v_pk_add_f32 v[120:121], v[120:121], v[78:79]
v_smfmac_f32_16x16x64_bf16 v[96:99], v[80:83], v[232:239], v126
v_cvt_pk_bf16_f32 v118, v72, v73
v_and_b32 v80, v118, v122
v_and_b32 v81, v118, v123
v_smfmac_f32_16x16x64_bf16 v[92:95], v[84:87], v[240:247], v126
v_and_b32 v82, v118, v124
v_and_b32 v83, v118, v125
v_add_f32 v115, v120, v121
v_smfmac_f32_16x16x64_bf16 v[96:99], v[84:87], v[248:255], v126
v_cvt_pk_bf16_f32 v118, v74, v75
v_and_b32 v84, v118, v122
v_and_b32 v85, v118, v123
v_smfmac_f32_16x16x64_bf16 v[100:103], v[80:83], a[192:199], v126
v_and_b32 v86, v118, v124
v_and_b32 v87, v118, v125
v_mov_b32 v117, v115
v_smfmac_f32_16x16x64_bf16 v[104:107], v[80:83], a[200:207], v126
v_cvt_pk_bf16_f32 v118, v76, v77
v_and_b32 v80, v118, v122
v_and_b32 v81, v118, v123
v_smfmac_f32_16x16x64_bf16 v[100:103], v[84:87], a[208:215], v126
v_and_b32 v82, v118, v124
v_and_b32 v83, v118, v125
v_smfmac_f32_16x16x64_bf16 v[104:107], v[84:87], a[216:223], v126
v_cvt_pk_bf16_f32 v118, v78, v79
v_and_b32 v84, v118, v122
v_and_b32 v85, v118, v123
v_smfmac_f32_16x16x64_bf16 v[100:103], v[80:83], a[224:231], v126
v_and_b32 v86, v118, v124
v_and_b32 v87, v118, v125
v_permlane16_swap_b32 v117, v115
v_smfmac_f32_16x16x64_bf16 v[104:107], v[80:83], a[232:239], v126
v_add_f32 v115, v115, v117
v_mov_b32 v117, v115
v_smfmac_f32_16x16x64_bf16 v[100:103], v[84:87], a[240:247], v126
s_nop 0
v_permlane32_swap_b32 v117, v115
v_add_f32 v115, v115, v117
v_smfmac_f32_16x16x64_bf16 v[104:107], v[84:87], a[248:255], v126
L_att_1:
ds_write_b128 v14, v[92:95] offset:0
ds_write_b128 v14, v[96:99] offset:512
s_mov_b64 exec, 0x101
ds_write_b64 v15, v[112:113]
ds_write_b64 v15, v[114:115] offset:64
s_mov_b64 exec, -1
ds_write_b128 v14, v[100:103] offset:2048
s_nop 0
ds_write_b128 v14, v[104:107] offset:2560
s_waitcnt lgkmcnt(0)
s_barrier
ds_read_b128 v[48:51], v17
ds_read_b128 v[52:55], v17 offset:16
ds_read_b128 v[32:35], v16 offset:0
ds_read_b128 v[36:39], v16 offset:4096
ds_read_b128 v[40:43], v16 offset:8192
ds_read_b128 v[44:47], v16 offset:12288
s_waitcnt lgkmcnt(4)
v_max3_f32 v56, v48, v50, v52
v_max_f32 v56, v56, v54
v_sub_f32 v48, v48, v56
v_sub_f32 v50, v50, v56
v_sub_f32 v52, v52, v56
v_sub_f32 v54, v54, v56
v_exp_f32 v48, v48
v_exp_f32 v50, v50
v_exp_f32 v52, v52
v_exp_f32 v54, v54
v_mul_f32 v57, v48, v49
v_fmac_f32 v57, v50, v51
v_fmac_f32 v57, v52, v53
v_fmac_f32 v57, v54, v55
v_rcp_f32 v58, v57
v_log_f32 v59, v57
s_waitcnt lgkmcnt(0)
v_pk_mul_f32 v[60:61], v[32:33], v[48:49] op_sel_hi:[1,0]
v_pk_mul_f32 v[62:63], v[34:35], v[48:49] op_sel_hi:[1,0]
v_add_f32 v59, v59, v56
v_pk_fma_f32 v[60:61], v[36:37], v[50:51], v[60:61] op_sel_hi:[1,0,1]
v_pk_fma_f32 v[62:63], v[38:39], v[50:51], v[62:63] op_sel_hi:[1,0,1]
v_pk_fma_f32 v[60:61], v[40:41], v[52:53], v[60:61] op_sel_hi:[1,0,1]
v_pk_fma_f32 v[62:63], v[42:43], v[52:53], v[62:63] op_sel_hi:[1,0,1]
v_pk_fma_f32 v[60:61], v[44:45], v[54:55], v[60:61] op_sel_hi:[1,0,1]
v_pk_fma_f32 v[62:63], v[46:47], v[54:55], v[62:63] op_sel_hi:[1,0,1]
v_min_u32 v59, -2, v59
v_pk_mul_f32 v[60:61], v[60:61], v[58:59] op_sel_hi:[1,0]
v_pk_mul_f32 v[62:63], v[62:63], v[58:59] op_sel_hi:[1,0]
v_cvt_pk_bf16_f32 v64, v60, v61
v_cvt_pk_bf16_f32 v65, v62, v63
v_min_u32 v64, -2, v64
v_min_u32 v65, -2, v65
s_cmp_lg_u32 s101, 0
s_cbranch_scc0 L_gs5
buffer_store_dwordx2 v[64:65], v3, s[52:55], s84 offen
s_mov_b64 exec, 1
buffer_store_dword v59, v6, s[52:55], s85 offen
s_mov_b64 exec, -1
L_gsb5:
s_cmp_lg_u32 s23, 0
s_cbranch_scc1 L_q_1
s_mov_b32 s88, 0
L_g1p_1:
buffer_load_dwordx4 v[64:67], v5, s[52:55], s79 offen sc1
buffer_load_dwordx4 v[68:71], v5, s[52:55], s79 offen offset:16 sc1
s_waitcnt vmcnt(0)
v_max3_u32 v79, v64, v65, v66
v_max3_u32 v78, v67, v68, v69
v_max3_u32 v79, v79, v70, v71
v_max_u32 v79, v79, v78
v_cmp_eq_u32 vcc, -1, v79
s_cbranch_vccz L_g1px_1
s_add_u32 s88, s88, 1
s_cmp_lt_u32 s88, 200000
s_cbranch_scc1 L_g1p_1
L_g1px_1:
buffer_load_dwordx4 v[32:35], v4, s[52:55], s81 offen offset:0 sc1
buffer_load_dwordx4 v[36:39], v4, s[52:55], s81 offen offset:1024 sc1
buffer_load_dwordx4 v[40:43], v4, s[52:55], s81 offen offset:2048 sc1
buffer_load_dwordx4 v[44:47], v4, s[52:55], s81 offen offset:3072 sc1
buffer_load_dwordx4 v[48:51], v4, s[52:55], s82 offen offset:0 sc1
buffer_load_dwordx4 v[52:55], v4, s[52:55], s82 offen offset:1024 sc1
buffer_load_dwordx4 v[56:59], v4, s[52:55], s82 offen offset:2048 sc1
buffer_load_dwordx4 v[60:63], v4, s[52:55], s82 offen offset:3072 sc1
v_mov_b32 v76, v122
v_mov_b32 v77, v123
v_mov_b32 v78, v124
v_mov_b32 v90, v125
v_mov_b32 v91, v126
ds_read_b64_tr_b16 v[96:97], v20 offset:0
ds_read_b64_tr_b16 v[98:99], v20 offset:128
ds_read_b64_tr_b16 v[100:101], v20 offset:1024
ds_read_b64_tr_b16 v[102:103], v20 offset:1152
ds_read_b64_tr_b16 v[104:105], v20 offset:2048
ds_read_b64_tr_b16 v[106:107], v20 offset:2176
ds_read_b64_tr_b16 v[108:109], v20 offset:3072
ds_read_b64_tr_b16 v[110:111], v20 offset:3200
ds_read_b64_tr_b16 v[112:113], v20 offset:4096
ds_read_b64_tr_b16 v[114:115], v20 offset:4224
ds_read_b64_tr_b16 v[116:117], v20 offset:5120
ds_read_b64_tr_b16 v[118:119], v20 offset:5248
s_waitcnt lgkmcnt(6)
ds_read_b64_tr_b16 v[120:121], v20 offset:6144
ds_read_b64_tr_b16 v[122:123], v20 offset:6272
ds_read_b64_tr_b16 v[124:125], v20 offset:7168
ds_read_b64_tr_b16 v[126:127], v20 offset:7296
L_g1c_1:
v_max3_f32 v72, v64, v65, v66
v_max3_f32 v73, v67, v68, v69
v_max3_f32 v72, v72, v70, v71
v_max_f32 v72, v72, v73
v_mov_b32 v73, v72
s_nop 1
v_permlane16_swap_b32 v73, v72
v_max_f32 v72, v72, v73
v_mov_b32 v73, v72
s_nop 1
v_permlane32_swap_b32 v73, v72
v_max_f32 v72, v72, v73
v_sub_f32 v64, v64, v72
v_sub_f32 v65, v65, v72
v_sub_f32 v66, v66, v72
v_sub_f32 v67, v67, v72
v_sub_f32 v68, v68, v72
v_sub_f32 v69, v69, v72
v_sub_f32 v70, v70, v72
v_sub_f32 v71, v71, v72
v_exp_f32 v64, v64
v_exp_f32 v65, v65
v_exp_f32 v66, v66
v_exp_f32 v67, v67
v_exp_f32 v68, v68
v_exp_f32 v69, v69
v_exp_f32 v70, v70
v_exp_f32 v71, v71
v_mov_b64 v[92:93], 0
v_mov_b64 v[94:95], 0
v_cvt_pk_bf16_f32 v88, v64, v65
v_cvt_pk_bf16_f32 v89, v66, v67
v_and_b32 v80, v88, v76
v_and_b32 v81, v88, v77
v_and_b32 v82, v88, v78
v_and_b32 v83, v88, v90
v_and_b32 v84, v89, v76
v_and_b32 v85, v89, v77
v_and_b32 v86, v89, v78
v_and_b32 v87, v89, v90
v_add_f32 v74, v64, v65
v_add_f32 v75, v66, v67
s_waitcnt vmcnt(0)
v_smfmac_f32_16x16x64_bf16 v[92:95], v[80:83], v[32:39], v91
v_cvt_pk_bf16_f32 v88, v68, v69
v_and_b32 v80, v88, v76
v_and_b32 v81, v88, v77
v_and_b32 v82, v88, v78
v_and_b32 v83, v88, v90
v_add_f32 v74, v74, v75
v_add_f32 v75, v68, v69
v_smfmac_f32_16x16x64_bf16 v[92:95], v[84:87], v[40:47], v91
v_cvt_pk_bf16_f32 v89, v70, v71
v_and_b32 v84, v89, v76
v_and_b32 v85, v89, v77
v_and_b32 v86, v89, v78
v_and_b32 v87, v89, v90
v_add_f32 v73, v70, v71
v_add_f32 v75, v75, v73
v_smfmac_f32_16x16x64_bf16 v[92:95], v[80:83], v[48:55], v91
v_add_f32 v74, v74, v75
v_mov_b32 v73, v74
s_nop 1
v_permlane16_swap_b32 v73, v74
v_add_f32 v74, v74, v73
v_smfmac_f32_16x16x64_bf16 v[92:95], v[84:87], v[56:63], v91
v_mov_b32 v73, v74
s_nop 1
v_permlane32_swap_b32 v73, v74
v_add_f32 v74, v74, v73
v_rcp_f32 v74, v74
s_nop 1
v_mul_f32 v92, v92, v74
v_mul_f32 v93, v93, v74
v_mul_f32 v94, v94, v74
v_mul_f32 v95, v95, v74
v_add_f32 v72, v92, v93
v_add_f32 v73, v94, v95
v_add_f32 v72, v72, v73
v_cmp_u_f32 vcc, v72, v72
s_cbranch_vccnz L_g1r_1
L_g1ok_1:
s_mov_b32 s89, 0
v_cvt_pk_bf16_f32 v76, v92, v93
v_cvt_pk_bf16_f32 v77, v94, v95
ds_write_b64 v18, v[76:77]
s_waitcnt lgkmcnt(0)
s_barrier
ds_read_b128 v[32:35], v19 offset:0
ds_read_b128 v[36:39], v19 offset:64
ds_read_b128 v[40:43], v19 offset:128
ds_read_b128 v[44:47], v19 offset:192
ds_read_b128 v[48:51], v19 offset:256
ds_read_b128 v[52:55], v19 offset:320
ds_read_b128 v[56:59], v19 offset:384
ds_read_b128 v[60:63], v19 offset:448
s_waitcnt lgkmcnt(7)
v_mfma_f32_16x16x32_bf16 v[92:95], v[96:99], v[32:35], 0
s_waitcnt lgkmcnt(6)
v_mfma_f32_16x16x32_bf16 v[92:95], v[100:103], v[36:39], v[92:95]
s_waitcnt lgkmcnt(5)
v_mfma_f32_16x16x32_bf16 v[92:95], v[104:107], v[40:43], v[92:95]
s_waitcnt lgkmcnt(4)
v_mfma_f32_16x16x32_bf16 v[92:95], v[108:111], v[44:47], v[92:95]
s_waitcnt lgkmcnt(3)
v_mfma_f32_16x16x32_bf16 v[92:95], v[112:115], v[48:51], v[92:95]
s_waitcnt lgkmcnt(2)
v_mfma_f32_16x16x32_bf16 v[92:95], v[116:119], v[52:55], v[92:95]
s_waitcnt lgkmcnt(1)
v_mfma_f32_16x16x32_bf16 v[92:95], v[120:123], v[56:59], v[92:95]
s_waitcnt lgkmcnt(0)
v_mfma_f32_16x16x32_bf16 v[92:95], v[124:127], v[60:63], v[92:95]
s_mov_b32 exec_lo, 0x00030003
s_cmp_eq_u32 s65, 3
s_cselect_b32 exec_hi, 0, 0x00030003
s_nop 4
v_cvt_pk_bf16_f32 v76, v92, v93
v_cvt_pk_bf16_f32 v77, v94, v95
v_min_u32 v76, -2, v76
v_min_u32 v77, -2, v77
buffer_store_dwordx2 v[76:77], v7, s[52:55], s80 offen sc1
s_mov_b64 exec, -1
s_cmp_eq_u32 s65, 0
s_cbranch_scc0 L_nof2_1
v_mov_b32 v78, s14
s_lshl_b32 s90, s66, 2
v_mov_b32 v79, s90
s_mov_b64 exec, 1
buffer_store_dword v78, v79, s[52:55], s17 offen sc1
s_mov_b64 exec, -1
L_nof2_1:
s_barrier
buffer_load_dwordx4 v[156:159], v1, s[44:47], s68 offen offset:896 nt
buffer_load_dwordx4 v[160:163], v1, s[44:47], s69 offen offset:0 nt
buffer_load_dwordx4 v[164:167], v1, s[44:47], s69 offen offset:128 nt
buffer_load_dwordx4 v[168:171], v1, s[44:47], s69 offen offset:256 nt
buffer_load_dwordx4 v[172:175], v1, s[44:47], s69 offen offset:384 nt
buffer_load_dwordx4 v[176:179], v1, s[44:47], s69 offen offset:512 nt
buffer_load_dwordx4 v[180:183], v1, s[44:47], s69 offen offset:640 nt
buffer_load_dwordx4 v[184:187], v1, s[44:47], s69 offen offset:768 nt
buffer_load_dwordx4 v[188:191], v1, s[44:47], s69 offen offset:896 nt
buffer_load_dwordx4 v[192:195], v2, s[48:51], s68 offen offset:0 nt
buffer_load_dwordx4 v[196:199], v2, s[48:51], s68 offen offset:2048 nt
buffer_load_dwordx4 v[200:203], v2, s[48:51], s68 offen offset:256 nt
buffer_load_dwordx4 v[204:207], v2, s[48:51], s68 offen offset:2304 nt
buffer_load_dwordx4 v[208:211], v2, s[48:51], s68 offen offset:1024 nt
buffer_load_dwordx4 v[212:215], v2, s[48:51], s68 offen offset:3072 nt
buffer_load_dwordx4 v[216:219], v2, s[48:51], s68 offen offset:1280 nt
buffer_load_dwordx4 v[220:223], v2, s[48:51], s68 offen offset:3328 nt
buffer_load_dwordx4 v[224:227], v2, s[48:51], s69 offen offset:0 nt
buffer_load_dwordx4 v[228:231], v2, s[48:51], s69 offen offset:2048 nt
buffer_load_dwordx4 v[232:235], v2, s[48:51], s69 offen offset:256 nt
buffer_load_dwordx4 v[236:239], v2, s[48:51], s69 offen offset:2304 nt
buffer_load_dwordx4 v[240:243], v2, s[48:51], s69 offen offset:1024 nt
buffer_load_dwordx4 v[244:247], v2, s[48:51], s69 offen offset:3072 nt
buffer_load_dwordx4 v[248:251], v2, s[48:51], s69 offen offset:1280 nt
buffer_load_dwordx4 v[252:255], v2, s[48:51], s69 offen offset:3328 nt
s_branch L_e_1
L_q_1:
s_barrier
buffer_load_dwordx4 v[156:159], v1, s[44:47], s68 offen offset:896 nt
buffer_load_dwordx4 v[160:163], v1, s[44:47], s69 offen offset:0 nt
buffer_load_dwordx4 v[164:167], v1, s[44:47], s69 offen offset:128 nt
buffer_load_dwordx4 v[168:171], v1, s[44:47], s69 offen offset:256 nt
buffer_load_dwordx4 v[172:175], v1, s[44:47], s69 offen offset:384 nt
buffer_load_dwordx4 v[176:179], v1, s[44:47], s69 offen offset:512 nt
buffer_load_dwordx4 v[180:183], v1, s[44:47], s69 offen offset:640 nt
buffer_load_dwordx4 v[184:187], v1, s[44:47], s69 offen offset:768 nt
buffer_load_dwordx4 v[188:191], v1, s[44:47], s69 offen offset:896 nt
buffer_load_dwordx4 v[192:195], v2, s[48:51], s68 offen offset:0 nt
buffer_load_dwordx4 v[196:199], v2, s[48:51], s68 offen offset:2048 nt
buffer_load_dwordx4 v[200:203], v2, s[48:51], s68 offen offset:256 nt
buffer_load_dwordx4 v[204:207], v2, s[48:51], s68 offen offset:2304 nt
buffer_load_dwordx4 v[208:211], v2, s[48:51], s68 offen offset:1024 nt
buffer_load_dwordx4 v[212:215], v2, s[48:51], s68 offen offset:3072 nt
buffer_load_dwordx4 v[216:219], v2, s[48:51], s68 offen offset:1280 nt
buffer_load_dwordx4 v[220:223], v2, s[48:51], s68 offen offset:3328 nt
buffer_load_dwordx4 v[224:227], v2, s[48:51], s69 offen offset:0 nt
buffer_load_dwordx4 v[228:231], v2, s[48:51], s69 offen offset:2048 nt
s_cmp_lg_u32 s65, 2
s_cbranch_scc1 L_nop2_1
s_mov_b32 s88, 0
L_hp_2_1:
s_load_dwordx8 s[4:11], s[40:41], s17 glc
s_waitcnt lgkmcnt(0)
s_xor_b64 s[4:5], s[4:5], s[14:15]
s_xor_b64 s[6:7], s[6:7], s[14:15]
s_xor_b64 s[8:9], s[8:9], s[14:15]
s_xor_b64 s[10:11], s[10:11], s[14:15]
s_or_b64 s[4:5], s[4:5], s[6:7]
s_or_b64 s[8:9], s[8:9], s[10:11]
s_or_b64 s[4:5], s[4:5], s[8:9]
s_cbranch_scc0 L_hpx_2_1
s_add_u32 s88, s88, 1
s_cmp_lt_u32 s88, 400
s_cbranch_scc1 L_hp_2_1
L_hpx_2_1:
L_nop2_1:
s_barrier
v_subrev_u32 v92, 98304, v23
v_subrev_u32 v93, 98304, v24
buffer_load_dwordx4 v[32:35], v8, s[52:55], s80 offen offset:0
buffer_load_dwordx4 v[36:39], v8, s[52:55], s80 offen offset:1024
buffer_load_dwordx4 v[40:43], v8, s[52:55], s80 offen offset:2048
buffer_load_dwordx4 v[44:47], v8, s[52:55], s80 offen offset:3072
buffer_load_dwordx4 v[48:51], v9, s[52:55], s80 offen offset:0
buffer_load_dwordx4 v[52:55], v9, s[52:55], s80 offen offset:1024
buffer_load_dwordx4 v[56:59], v9, s[52:55], s80 offen offset:2048
buffer_load_dwordx4 v[60:63], v9, s[52:55], s80 offen offset:3072
buffer_load_dwordx2 v[84:85], v92, s[60:63], s24 offen
buffer_load_dwordx2 v[88:89], v93, s[60:63], s24 offen
s_barrier
buffer_load_dwordx4 v[232:235], v2, s[48:51], s69 offen offset:256 nt
buffer_load_dwordx4 v[236:239], v2, s[48:51], s69 offen offset:2304 nt
buffer_load_dwordx4 v[240:243], v2, s[48:51], s69 offen offset:1024 nt
buffer_load_dwordx4 v[244:247], v2, s[48:51], s69 offen offset:3072 nt
buffer_load_dwordx4 v[248:251], v2, s[48:51], s69 offen offset:1280 nt
buffer_load_dwordx4 v[252:255], v2, s[48:51], s69 offen offset:3328 nt
v_mov_b32 v94, 0x3f803f80
v_and_b32 v80, v94, v122
v_and_b32 v81, v94, v123
v_and_b32 v82, v94, v124
v_and_b32 v83, v94, v125
v_mov_b32 v90, v126
v_subrev_u32 v76, 98304, v23
v_subrev_u32 v76, s71, v76
v_subrev_u32 v77, 98304, v24
v_subrev_u32 v77, s71, v77
v_min_u32 v78, 0x378, v76
v_add_u32 v78, s72, v78
v_min_u32 v79, 0x378, v77
v_add_u32 v79, s72, v79
ds_read_b64 v[72:73], v78
ds_read_b64 v[74:75], v79
s_cmp_gt_u32 s65, 1
s_cbranch_scc1 L_nowq_1
ds_read_b64_tr_b16 v[96:97], v21 offset:0
ds_read_b64_tr_b16 v[98:99], v21 offset:128
ds_read_b64_tr_b16 v[100:101], v21 offset:1024
ds_read_b64_tr_b16 v[102:103], v21 offset:1152
ds_read_b64_tr_b16 v[104:105], v21 offset:2048
ds_read_b64_tr_b16 v[106:107], v21 offset:2176
ds_read_b64_tr_b16 v[108:109], v21 offset:3072
ds_read_b64_tr_b16 v[110:111], v21 offset:3200
ds_read_b64_tr_b16 v[112:113], v21 offset:4096
ds_read_b64_tr_b16 v[114:115], v21 offset:4224
ds_read_b64_tr_b16 v[116:117], v21 offset:5120
ds_read_b64_tr_b16 v[118:119], v21 offset:5248
s_waitcnt lgkmcnt(6)
ds_read_b64_tr_b16 v[120:121], v21 offset:6144
ds_read_b64_tr_b16 v[122:123], v21 offset:6272
ds_read_b64_tr_b16 v[124:125], v21 offset:7168
ds_read_b64_tr_b16 v[126:127], v21 offset:7296
L_nowq_1:
s_waitcnt vmcnt(6)
L_g2c_1:
v_lshlrev_b32 v64, 16, v84
v_and_b32 v65, 0xffff0000, v84
v_lshlrev_b32 v66, 16, v85
v_and_b32 v67, 0xffff0000, v85
v_lshlrev_b32 v68, 16, v88
v_and_b32 v69, 0xffff0000, v88
v_lshlrev_b32 v70, 16, v89
v_and_b32 v71, 0xffff0000, v89
v_smfmac_f32_16x16x64_bf16 v[64:67], v[80:83], v[32:39], v90
s_nop 0
v_smfmac_f32_16x16x64_bf16 v[68:71], v[80:83], v[48:55], v90
v_smfmac_f32_16x16x64_bf16 v[64:67], v[80:83], v[40:47], v90
v_smfmac_f32_16x16x64_bf16 v[68:71], v[80:83], v[56:63], v90
s_nop 6
v_add_f32 v92, v64, v65
v_add_f32 v93, v66, v67
v_add_f32 v94, v68, v69
v_add_f32 v95, v70, v71
v_add_f32 v92, v92, v93
v_add_f32 v94, v94, v95
v_add_f32 v92, v92, v94
v_cmp_u_f32 vcc, v92, v92
s_cbranch_vccnz L_g2r_1
L_g2ok_1:
s_mov_b32 s89, 0
v_cvt_pk_bf16_f32 v64, v64, v65
v_cvt_pk_bf16_f32 v65, v66, v67
v_cvt_pk_bf16_f32 v66, v68, v69
v_cvt_pk_bf16_f32 v67, v70, v71
s_waitcnt lgkmcnt(0)
s_cmp_eq_u32 s70, 0
s_cbranch_scc1 L_xw_1
s_movk_i32 s90, 896
v_cmp_gt_u32 vcc, s90, v76
s_cmp_eq_u32 s74, 0
s_cselect_b32 s91, 1, 0
s_cmp_ge_u32 s64, 2
s_cselect_b32 s91, s91, 0
s_cmp_eq_u32 s91, 0
s_cbranch_scc1 L_noout_1
s_and_b64 s[92:93], vcc, exec
s_mov_b32 s93, 0
s_mov_b64 exec, s[92:93]
buffer_store_dwordx2 v[64:65], v76, s[56:59], s73 offen
s_mov_b64 exec, -1
s_movk_i32 s90, 896
v_cmp_gt_u32 s[92:93], s90, v77
s_mov_b32 s93, 0
s_mov_b64 exec, s[92:93]
buffer_store_dwordx2 v[66:67], v77, s[56:59], s73 offen
s_mov_b64 exec, -1
L_noout_1:
s_movk_i32 s90, 896
v_cmp_gt_u32 vcc, s90, v76
s_nop 1
v_cndmask_b32 v64, v64, v72, vcc
v_cndmask_b32 v65, v65, v73, vcc
v_cmp_gt_u32 vcc, s90, v77
s_nop 1
v_cndmask_b32 v66, v66, v74, vcc
v_cndmask_b32 v67, v67, v75, vcc
L_xw_1:
ds_write_b64 v23, v[64:65]
ds_write_b64 v24, v[66:67]
s_cmp_lg_u32 s66, 0
s_cbranch_scc1 L_noxs_1
s_cmp_lg_u32 s27, 0
s_cbranch_scc1 L_noxs_1
v_min_u32 v68, -2, v64
v_min_u32 v69, -2, v65
v_min_u32 v70, -2, v66
v_min_u32 v71, -2, v67
v_subrev_u32 v92, 98304, v23
v_subrev_u32 v93, 98304, v24
s_mov_b32 exec_hi, 0
buffer_store_dwordx2 v[68:69], v92, s[52:55], s25 offen sc1
buffer_store_dwordx2 v[70:71], v93, s[52:55], s25 offen sc1
s_mov_b32 exec_hi, -1
L_noxs_1:
s_cmp_eq_u32 s64, 17
s_cbranch_scc1 L_e_1
L_qp_1:
s_mov_b32 s76, 77824
s_mov_b32 s42, 45056
s_waitcnt lgkmcnt(0)
s_barrier
s_cmp_gt_u32 s65, 1
s_cbranch_scc1 L_e_1
ds_read_b128 v[32:35], v22 offset:0
ds_read_b128 v[36:39], v22 offset:64
ds_read_b128 v[40:43], v22 offset:128
ds_read_b128 v[44:47], v22 offset:192
ds_read_b128 v[48:51], v22 offset:256
ds_read_b128 v[52:55], v22 offset:320
ds_read_b128 v[56:59], v22 offset:384
ds_read_b128 v[60:63], v22 offset:448
ds_read_b128 v[64:67], v22 offset:512
ds_read_b128 v[68:71], v22 offset:576
ds_read_b128 v[72:75], v22 offset:640
ds_read_b128 v[76:79], v22 offset:704
ds_read_b128 v[80:83], v22 offset:768
ds_read_b128 v[84:87], v22 offset:832
s_waitcnt lgkmcnt(7)
v_mfma_f32_16x16x32_bf16 v[92:95], v[96:99], v[32:35], 0
v_mfma_f32_16x16x32_bf16 v[88:91], v[32:35], v[32:35], 0
ds_read_b64_tr_b16 v[96:97], v21 offset:8192
ds_read_b64_tr_b16 v[98:99], v21 offset:8320
v_mfma_f32_16x16x32_bf16 v[92:95], v[100:103], v[36:39], v[92:95]
v_mfma_f32_16x16x32_bf16 v[88:91], v[36:39], v[36:39], v[88:91]
ds_read_b64_tr_b16 v[100:101], v21 offset:9216
ds_read_b64_tr_b16 v[102:103], v21 offset:9344
v_mfma_f32_16x16x32_bf16 v[92:95], v[104:107], v[40:43], v[92:95]
v_mfma_f32_16x16x32_bf16 v[88:91], v[40:43], v[40:43], v[88:91]
ds_read_b64_tr_b16 v[104:105], v21 offset:10240
ds_read_b64_tr_b16 v[106:107], v21 offset:10368
v_mfma_f32_16x16x32_bf16 v[92:95], v[108:111], v[44:47], v[92:95]
v_mfma_f32_16x16x32_bf16 v[88:91], v[44:47], v[44:47], v[88:91]
ds_read_b64_tr_b16 v[108:109], v21 offset:11264
ds_read_b64_tr_b16 v[110:111], v21 offset:11392
s_waitcnt lgkmcnt(8)
v_mfma_f32_16x16x32_bf16 v[92:95], v[112:115], v[48:51], v[92:95]
v_mfma_f32_16x16x32_bf16 v[88:91], v[48:51], v[48:51], v[88:91]
ds_read_b64_tr_b16 v[112:113], v21 offset:12288
ds_read_b64_tr_b16 v[114:115], v21 offset:12416
v_mfma_f32_16x16x32_bf16 v[92:95], v[116:119], v[52:55], v[92:95]
v_mfma_f32_16x16x32_bf16 v[88:91], v[52:55], v[52:55], v[88:91]
ds_read_b64_tr_b16 v[116:117], v21 offset:13312
ds_read_b64_tr_b16 v[118:119], v21 offset:13440
v_mfma_f32_16x16x32_bf16 v[92:95], v[120:123], v[56:59], v[92:95]
v_mfma_f32_16x16x32_bf16 v[88:91], v[56:59], v[56:59], v[88:91]
v_mfma_f32_16x16x32_bf16 v[92:95], v[124:127], v[60:63], v[92:95]
v_mfma_f32_16x16x32_bf16 v[88:91], v[60:63], v[60:63], v[88:91]
s_waitcnt lgkmcnt(10)
v_mfma_f32_16x16x32_bf16 v[92:95], v[96:99], v[64:67], v[92:95]
v_mfma_f32_16x16x32_bf16 v[88:91], v[64:67], v[64:67], v[88:91]
s_waitcnt lgkmcnt(8)
v_mfma_f32_16x16x32_bf16 v[92:95], v[100:103], v[68:71], v[92:95]
v_mfma_f32_16x16x32_bf16 v[88:91], v[68:71], v[68:71], v[88:91]
s_waitcnt lgkmcnt(6)
v_mfma_f32_16x16x32_bf16 v[92:95], v[104:107], v[72:75], v[92:95]
v_mfma_f32_16x16x32_bf16 v[88:91], v[72:75], v[72:75], v[88:91]
s_waitcnt lgkmcnt(4)
v_mfma_f32_16x16x32_bf16 v[92:95], v[108:111], v[76:79], v[92:95]
v_mfma_f32_16x16x32_bf16 v[88:91], v[76:79], v[76:79], v[88:91]
s_waitcnt lgkmcnt(2)
v_mfma_f32_16x16x32_bf16 v[92:95], v[112:115], v[80:83], v[92:95]
v_mfma_f32_16x16x32_bf16 v[88:91], v[80:83], v[80:83], v[88:91]
s_waitcnt lgkmcnt(0)
v_mfma_f32_16x16x32_bf16 v[92:95], v[116:119], v[84:87], v[92:95]
v_mfma_f32_16x16x32_bf16 v[88:91], v[84:87], v[84:87], v[88:91]
v_and_b32 v32, 1, v0
v_cmp_eq_u32 vcc, 1, v32
v_mov_b32 v34, 0x3b124925
s_nop 4
v_cndmask_b32 v33, v88, v89, vcc
v_mul_f32 v35, v90, v34
v_mul_f32 v33, v33, v34
v_fma_f32 v33, -v35, v35, v33
v_max_f32 v33, 0, v33
v_add_f32 v33, 0x3727c5ac, v33
v_rsq_f32 v33, v33
v_sub_f32 v35, 0, v35
s_nop 1
v_fmac_f32_dpp v92, v92, v35 row_shl:2 row_mask:0xf bank_mask:0xf
v_fmac_f32_dpp v93, v93, v35 row_shl:2 row_mask:0xf bank_mask:0xf
v_fmac_f32_dpp v94, v94, v35 row_shl:2 row_mask:0xf bank_mask:0xf
v_fmac_f32_dpp v95, v95, v35 row_shl:2 row_mask:0xf bank_mask:0xf
v_mul_f32 v92, v92, v33
v_mul_f32 v93, v93, v33
v_mul_f32 v94, v94, v33
v_mul_f32 v95, v95, v33
v_mov_b32 v40, -1
v_mov_b32 v41, -1
v_cvt_pk_bf16_f32 v36, v92, v93
v_cvt_pk_bf16_f32 v37, v94, v95
v_min_u32 v36, -2, v36
v_min_u32 v37, -2, v37
s_mov_b32 exec_lo, 0x00030003
s_mov_b32 exec_hi, 0x00030003
s_cmp_lg_u32 s101, 0
s_cbranch_scc0 L_gs6
buffer_store_dwordx2 v[36:37], v10, s[52:55], s76 offen
buffer_store_dwordx2 v[40:41], v10, s[52:55], s42 offen
L_gsb6:
s_mov_b64 exec, -1
L_e_1:
s_add_u32 s64, s64, 1
s_cmp_eq_u32 s64, 0
s_cbranch_scc1 L_top0
s_add_u32 s14, s14, 0x01010101
s_mov_b32 s15, s14
s_mov_b32 s60, s40
s_mov_b32 s61, s41
s_mov_b32 s62, 67108864
s_lshl_b32 s91, s64, 11
s_add_u32 s24, s91, 622592
s_cmp_ge_u32 s64, 18
s_cbranch_scc1 L_end
L_top2:
s_lshr_b32 s91, s64, 1
s_and_b32 s91, s91, 1
s_lshl_b32 s91, s91, 13
s_add_u32 s78, s91, 77824
s_xor_b32 s91, s91, 8192
s_add_u32 s77, s91, 77824
s_mov_b32 s88, 0
buffer_load_dwordx4 v[112:115], v11, s[52:55], s77 offen sc1
buffer_load_dwordx4 v[116:119], v11, s[52:55], s78 offen sc1
s_xor_b32 s91, s64, s26
s_and_b32 s23, s91, 1
s_add_u32 s90, s64, 1
s_lshr_b32 s91, s90, 1
s_lshl_b32 s68, s91, 24
s_add_u32 s69, s68, 8192
s_cmp_lt_u32 s90, 16
s_cselect_b32 s92, 0x08000000, 0
s_mov_b32 s46, s92
s_mov_b32 s50, s92
s_cselect_b32 s68, s68, 0
s_cselect_b32 s69, s69, 0
s_bitcmp1_b32 s90, 0
s_cselect_b32 s44, s28, s18
s_cselect_b32 s45, s29, s19
s_cselect_b32 s48, s30, s20
s_cselect_b32 s49, s31, s21
s_mov_b32 s79, 102400
s_mul_i32 s91, s64, 28672
s_add_u32 s80, s91, 106496
s_mov_b32 s81, 1710080
s_mov_b32 s82, 1714176
s_lshr_b32 s92, s65, 1
s_lshl_b32 s91, s92, 15
s_add_u32 s83, s91, 661504
s_lshl_b32 s91, s92, 8
s_add_u32 s43, s91, 94208
s_lshr_b32 s86, s64, 1
s_and_b32 s86, s86, 1
s_xor_b32 s93, s86, s92
s_xor_b32 s93, s93, 1
s_lshl_b32 s91, s93, 15
s_add_u32 s84, s81, s91
s_lshl_b32 s91, s93, 8
s_add_u32 s85, s79, s91
s_and_b32 s70, s64, 1
s_xor_b32 s91, s86, 1
s_mul_i32 s71, s91, 896
s_lshr_b32 s91, s64, 1
s_add_u32 s93, s91, 1
s_min_u32 s93, s93, 7
s_mul_i32 s72, s93, 896
s_add_u32 s72, s72, 90112
s_sub_u32 s73, s91, 1
s_mul_i32 s73, s73, 896
s_lshl_b32 s91, s64, 11
s_add_u32 s25, s91, 624640
v_and_b32 v126, 4, v0
v_cmp_eq_u32 vcc, 0, v126
v_mov_b32 v125, 0xffff
s_nop 0
v_cndmask_b32 v122, 0, v125, vcc
v_xor_b32 v123, v122, v125
v_lshlrev_b32 v124, 16, v122
v_lshlrev_b32 v125, 16, v123
v_and_b32 v126, 3, v0
v_mul_u32_u24 v126, 0x5555, v126
v_mov_b32 v120, -1
v_mov_b32 v121, -1
s_cmp_lg_u32 s101, 0
s_cbranch_scc0 L_gs7
buffer_store_dwordx2 v[120:121], v3, s[52:55], s83 offen
s_mov_b64 exec, 1
buffer_store_dword v120, v6, s[52:55], s43 offen
s_mov_b64 exec, -1
L_gsb7:
s_waitcnt vmcnt(2)
v_max3_u32 v120, v112, v113, v114
v_max3_u32 v121, v115, v116, v117
v_max3_u32 v120, v120, v118, v119
v_max_u32 v120, v120, v121
v_cmp_eq_u32 vcc, -1, v120
s_cbranch_vccz L_g3px_2
L_g3p_2:
buffer_load_dwordx4 v[112:115], v11, s[52:55], s77 offen sc1
buffer_load_dwordx4 v[116:119], v11, s[52:55], s78 offen sc1
s_waitcnt vmcnt(0)
v_max3_u32 v120, v112, v113, v114
v_max3_u32 v121, v115, v116, v117
v_max3_u32 v120, v120, v118, v119
v_max_u32 v120, v120, v121
v_cmp_eq_u32 vcc, -1, v120
s_cbranch_vccz L_g3px_2
s_add_u32 s88, s88, 1
s_cmp_lt_u32 s88, 200000
s_cbranch_scc1 L_g3p_2
L_g3px_2:
ds_write_b128 v12, v[112:115]
ds_write_b128 v12, v[116:119] offset:1024
ds_read_b128 v[32:35], v13 offset:0
ds_read_b128 v[36:39], v13 offset:128
ds_read_b128 v[40:43], v13 offset:256
ds_read_b128 v[44:47], v13 offset:384
ds_read_b128 v[48:51], v13 offset:1024
ds_read_b128 v[52:55], v13 offset:1152
ds_read_b128 v[56:59], v13 offset:1280
ds_read_b128 v[60:63], v13 offset:1408
v_mov_b32 v127, 0x3db8aa3b
s_cmp_ge_u32 s64, 16
s_cbranch_scc1 L_oo_2
s_waitcnt lgkmcnt(7)
v_mfma_f32_16x16x32_bf16 v[80:83], a[0:3], v[32:35], 0
v_mfma_f32_16x16x32_bf16 v[84:87], a[16:19], v[32:35], 0
s_waitcnt lgkmcnt(6)
v_mfma_f32_16x16x32_bf16 v[80:83], a[4:7], v[36:39], v[80:83]
v_mfma_f32_16x16x32_bf16 v[84:87], a[20:23], v[36:39], v[84:87]
s_waitcnt lgkmcnt(5)
v_mfma_f32_16x16x32_bf16 v[80:83], a[8:11], v[40:43], v[80:83]
v_mfma_f32_16x16x32_bf16 v[84:87], a[24:27], v[40:43], v[84:87]
s_waitcnt lgkmcnt(4)
v_mfma_f32_16x16x32_bf16 v[80:83], a[12:15], v[44:47], v[80:83]
v_mfma_f32_16x16x32_bf16 v[84:87], a[28:31], v[44:47], v[84:87]
v_mfma_f32_16x16x32_bf16 v[88:91], a[32:35], v[32:35], 0
buffer_load_dwordx4 a[0:3], v1, s[44:47], s68 offen offset:0 nt
v_mfma_f32_16x16x32_bf16 v[92:95], a[48:51], v[32:35], 0
buffer_load_dwordx4 a[4:7], v1, s[44:47], s68 offen offset:128 nt
v_mfma_f32_16x16x32_bf16 v[88:91], a[36:39], v[36:39], v[88:91]
buffer_load_dwordx4 a[8:11], v1, s[44:47], s68 offen offset:256 nt
v_mfma_f32_16x16x32_bf16 v[92:95], a[52:55], v[36:39], v[92:95]
buffer_load_dwordx4 a[12:15], v1, s[44:47], s68 offen offset:384 nt
v_mfma_f32_16x16x32_bf16 v[88:91], a[40:43], v[40:43], v[88:91]
buffer_load_dwordx4 a[16:19], v1, s[44:47], s68 offen offset:512 nt
v_mfma_f32_16x16x32_bf16 v[92:95], a[56:59], v[40:43], v[92:95]
buffer_load_dwordx4 a[20:23], v1, s[44:47], s68 offen offset:640 nt
v_mfma_f32_16x16x32_bf16 v[88:91], a[44:47], v[44:47], v[88:91]
buffer_load_dwordx4 a[24:27], v1, s[44:47], s68 offen offset:768 nt
v_mfma_f32_16x16x32_bf16 v[92:95], a[60:63], v[44:47], v[92:95]
s_waitcnt lgkmcnt(3)
v_mfma_f32_16x16x32_bf16 v[96:99], v[128:131], v[48:51], 0
v_add_f32_dpp v64, v81, v80 quad_perm:[1,0,3,2] row_mask:0xf bank_mask:0xf
v_add_f32_dpp v65, v85, v84 quad_perm:[1,0,3,2] row_mask:0xf bank_mask:0xf
v_mfma_f32_16x16x32_bf16 v[100:103], v[144:147], v[48:51], 0
v_add_f32_dpp v66, v83, v82 quad_perm:[1,0,3,2] row_mask:0xf bank_mask:0xf
v_add_f32_dpp v67, v87, v86 quad_perm:[1,0,3,2] row_mask:0xf bank_mask:0xf
v_mfma_f32_16x16x32_bf16 v[104:107], v[160:163], v[48:51], 0
v_add_f32_dpp v68, v89, v88 quad_perm:[1,0,3,2] row_mask:0xf bank_mask:0xf
v_add_f32_dpp v69, v93, v92 quad_perm:[1,0,3,2] row_mask:0xf bank_mask:0xf
v_mfma_f32_16x16x32_bf16 v[108:111], v[176:179], v[48:51], 0
v_add_f32_dpp v70, v91, v90 quad_perm:[1,0,3,2] row_mask:0xf bank_mask:0xf
v_add_f32_dpp v71, v95, v94 quad_perm:[1,0,3,2] row_mask:0xf bank_mask:0xf
s_waitcnt lgkmcnt(2)
v_mfma_f32_16x16x32_bf16 v[96:99], v[132:135], v[52:55], v[96:99]
v_max3_f32 v112, v64, v65, v66
v_max3_f32 v116, v67, v68, v69
v_mfma_f32_16x16x32_bf16 v[100:103], v[148:151], v[52:55], v[100:103]
v_max3_f32 v112, v112, v70, v71
v_max_f32 v112, v112, v116
v_mfma_f32_16x16x32_bf16 v[104:107], v[164:167], v[52:55], v[104:107]
v_mov_b32 v116, v112
s_nop 1
v_permlane16_swap_b32 v116, v112
v_mfma_f32_16x16x32_bf16 v[108:111], v[180:183], v[52:55], v[108:111]
v_max_f32 v112, v112, v116
v_mov_b32 v116, v112
s_waitcnt lgkmcnt(1)
v_mfma_f32_16x16x32_bf16 v[96:99], v[136:139], v[56:59], v[96:99]
v_permlane32_swap_b32 v116, v112
v_max_f32 v112, v112, v116
v_mfma_f32_16x16x32_bf16 v[100:103], v[152:155], v[56:59], v[100:103]
v_mul_f32 v112, v112, v127
v_pk_fma_f32 v[64:65], v[64:65], v[126:127], v[112:113] op_sel:[0,1,0] op_sel_hi:[1,1,0] neg_lo:[0,0,1] neg_hi:[0,0,1]
v_mfma_f32_16x16x32_bf16 v[104:107], v[168:171], v[56:59], v[104:107]
v_pk_fma_f32 v[66:67], v[66:67], v[126:127], v[112:113] op_sel:[0,1,0] op_sel_hi:[1,1,0] neg_lo:[0,0,1] neg_hi:[0,0,1]
v_pk_fma_f32 v[68:69], v[68:69], v[126:127], v[112:113] op_sel:[0,1,0] op_sel_hi:[1,1,0] neg_lo:[0,0,1] neg_hi:[0,0,1]
v_mfma_f32_16x16x32_bf16 v[108:111], v[184:187], v[56:59], v[108:111]
v_pk_fma_f32 v[70:71], v[70:71], v[126:127], v[112:113] op_sel:[0,1,0] op_sel_hi:[1,1,0] neg_lo:[0,0,1] neg_hi:[0,0,1]
v_exp_f32_dpp v64, v64 quad_perm:[0,0,2,2] row_mask:0xf bank_mask:0xf
s_waitcnt lgkmcnt(0)
v_mfma_f32_16x16x32_bf16 v[96:99], v[140:143], v[60:63], v[96:99]
v_exp_f32_dpp v65, v65 quad_perm:[0,0,2,2] row_mask:0xf bank_mask:0xf
v_exp_f32_dpp v66, v66 quad_perm:[0,0,2,2] row_mask:0xf bank_mask:0xf
v_mfma_f32_16x16x32_bf16 v[100:103], v[156:159], v[60:63], v[100:103]
v_exp_f32_dpp v67, v67 quad_perm:[0,0,2,2] row_mask:0xf bank_mask:0xf
v_exp_f32_dpp v68, v68 quad_perm:[0,0,2,2] row_mask:0xf bank_mask:0xf
v_mfma_f32_16x16x32_bf16 v[104:107], v[172:175], v[60:63], v[104:107]
v_exp_f32_dpp v69, v69 quad_perm:[0,0,2,2] row_mask:0xf bank_mask:0xf
v_exp_f32_dpp v70, v70 quad_perm:[0,0,2,2] row_mask:0xf bank_mask:0xf
v_mfma_f32_16x16x32_bf16 v[108:111], v[188:191], v[60:63], v[108:111]
v_exp_f32_dpp v71, v71 quad_perm:[0,0,2,2] row_mask:0xf bank_mask:0xf
v_mov_b64 v[92:93], 0
v_mov_b64 v[94:95], 0
v_pk_add_f32 v[118:119], v[64:65], v[66:67]
v_pk_add_f32 v[118:119], v[118:119], v[68:69]
v_pk_add_f32 v[118:119], v[118:119], v[70:71]
v_add_f32 v113, v118, v119
v_add_f32_dpp v72, v97, v96 quad_perm:[1,0,3,2] row_mask:0xf bank_mask:0xf
v_add_f32_dpp v73, v101, v100 quad_perm:[1,0,3,2] row_mask:0xf bank_mask:0xf
v_add_f32_dpp v74, v99, v98 quad_perm:[1,0,3,2] row_mask:0xf bank_mask:0xf
v_add_f32_dpp v75, v103, v102 quad_perm:[1,0,3,2] row_mask:0xf bank_mask:0xf
v_add_f32_dpp v76, v105, v104 quad_perm:[1,0,3,2] row_mask:0xf bank_mask:0xf
v_add_f32_dpp v77, v109, v108 quad_perm:[1,0,3,2] row_mask:0xf bank_mask:0xf
v_add_f32_dpp v78, v107, v106 quad_perm:[1,0,3,2] row_mask:0xf bank_mask:0xf
v_add_f32_dpp v79, v111, v110 quad_perm:[1,0,3,2] row_mask:0xf bank_mask:0xf
v_max3_f32 v114, v72, v73, v74
v_mov_b64 v[96:97], 0
v_max3_f32 v117, v75, v76, v77
v_mov_b64 v[98:99], 0
v_max3_f32 v114, v114, v78, v79
v_mov_b64 v[100:101], 0
v_max_f32 v114, v114, v117
v_mov_b64 v[102:103], 0
v_mov_b32 v117, v114
v_mov_b64 v[104:105], 0
v_mov_b64 v[106:107], 0
v_permlane16_swap_b32 v117, v114
v_max_f32 v114, v114, v117
v_mov_b32 v117, v114
v_mov_b32 v116, v113
v_cvt_pk_bf16_f32 v118, v64, v65
v_permlane32_swap_b32 v117, v114
v_permlane16_swap_b32 v116, v113
v_max_f32 v114, v114, v117
v_add_f32 v113, v113, v116
v_mul_f32 v114, v114, v127
v_mov_b32 v116, v113
v_pk_fma_f32 v[72:73], v[72:73], v[126:127], v[114:115] op_sel:[0,1,0] op_sel_hi:[1,1,0] neg_lo:[0,0,1] neg_hi:[0,0,1]
v_pk_fma_f32 v[74:75], v[74:75], v[126:127], v[114:115] op_sel:[0,1,0] op_sel_hi:[1,1,0] neg_lo:[0,0,1] neg_hi:[0,0,1]
v_permlane32_swap_b32 v116, v113
v_pk_fma_f32 v[76:77], v[76:77], v[126:127], v[114:115] op_sel:[0,1,0] op_sel_hi:[1,1,0] neg_lo:[0,0,1] neg_hi:[0,0,1]
v_add_f32 v113, v113, v116
v_pk_fma_f32 v[78:79], v[78:79], v[126:127], v[114:115] op_sel:[0,1,0] op_sel_hi:[1,1,0] neg_lo:[0,0,1] neg_hi:[0,0,1]
v_exp_f32_dpp v72, v72 quad_perm:[0,0,2,2] row_mask:0xf bank_mask:0xf
v_exp_f32_dpp v73, v73 quad_perm:[0,0,2,2] row_mask:0xf bank_mask:0xf
v_exp_f32_dpp v74, v74 quad_perm:[0,0,2,2] row_mask:0xf bank_mask:0xf
v_exp_f32_dpp v75, v75 quad_perm:[0,0,2,2] row_mask:0xf bank_mask:0xf
v_exp_f32_dpp v76, v76 quad_perm:[0,0,2,2] row_mask:0xf bank_mask:0xf
v_exp_f32_dpp v77, v77 quad_perm:[0,0,2,2] row_mask:0xf bank_mask:0xf
v_exp_f32_dpp v78, v78 quad_perm:[0,0,2,2] row_mask:0xf bank_mask:0xf
v_exp_f32_dpp v79, v79 quad_perm:[0,0,2,2] row_mask:0xf bank_mask:0xf
v_and_b32 v80, v118, v122
v_and_b32 v81, v118, v123
v_and_b32 v82, v118, v124
v_and_b32 v83, v118, v125
v_cvt_pk_bf16_f32 v118, v66, v67
v_and_b32 v84, v118, v122
v_and_b32 v85, v118, v123
v_smfmac_f32_16x16x64_bf16 v[92:95], v[80:83], a[64:71], v126
v_and_b32 v86, v118, v124
v_and_b32 v87, v118, v125
v_pk_add_f32 v[120:121], v[72:73], v[74:75]
v_smfmac_f32_16x16x64_bf16 v[96:99], v[80:83], a[72:79], v126
v_cvt_pk_bf16_f32 v118, v68, v69
v_and_b32 v80, v118, v122
v_and_b32 v81, v118, v123
v_smfmac_f32_16x16x64_bf16 v[92:95], v[84:87], a[80:87], v126
v_and_b32 v82, v118, v124
v_and_b32 v83, v118, v125
v_pk_add_f32 v[120:121], v[120:121], v[76:77]
v_smfmac_f32_16x16x64_bf16 v[96:99], v[84:87], a[88:95], v126
v_cvt_pk_bf16_f32 v118, v70, v71
v_and_b32 v84, v118, v122
v_and_b32 v85, v118, v123
v_smfmac_f32_16x16x64_bf16 v[92:95], v[80:83], a[96:103], v126
v_and_b32 v86, v118, v124
v_and_b32 v87, v118, v125
v_pk_add_f32 v[120:121], v[120:121], v[78:79]
v_smfmac_f32_16x16x64_bf16 v[96:99], v[80:83], a[104:111], v126
v_cvt_pk_bf16_f32 v118, v72, v73
v_and_b32 v80, v118, v122
v_and_b32 v81, v118, v123
v_smfmac_f32_16x16x64_bf16 v[92:95], v[84:87], a[112:119], v126
v_and_b32 v82, v118, v124
v_and_b32 v83, v118, v125
v_add_f32 v115, v120, v121
v_smfmac_f32_16x16x64_bf16 v[96:99], v[84:87], a[120:127], v126
v_cvt_pk_bf16_f32 v118, v74, v75
v_and_b32 v84, v118, v122
v_and_b32 v85, v118, v123
v_smfmac_f32_16x16x64_bf16 v[100:103], v[80:83], v[192:199], v126
v_and_b32 v86, v118, v124
v_and_b32 v87, v118, v125
v_mov_b32 v117, v115
v_smfmac_f32_16x16x64_bf16 v[104:107], v[80:83], v[200:207], v126
v_cvt_pk_bf16_f32 v118, v76, v77
v_and_b32 v80, v118, v122
v_and_b32 v81, v118, v123
v_smfmac_f32_16x16x64_bf16 v[100:103], v[84:87], v[208:215], v126
v_and_b32 v82, v118, v124
v_and_b32 v83, v118, v125
v_smfmac_f32_16x16x64_bf16 v[104:107], v[84:87], v[216:223], v126
v_cvt_pk_bf16_f32 v118, v78, v79
v_and_b32 v84, v118, v122
v_and_b32 v85, v118, v123
v_smfmac_f32_16x16x64_bf16 v[100:103], v[80:83], v[224:231], v126
v_and_b32 v86, v118, v124
v_and_b32 v87, v118, v125
v_permlane16_swap_b32 v117, v115
v_smfmac_f32_16x16x64_bf16 v[104:107], v[80:83], v[232:239], v126
v_add_f32 v115, v115, v117
v_mov_b32 v117, v115
v_smfmac_f32_16x16x64_bf16 v[100:103], v[84:87], v[240:247], v126
s_nop 0
v_permlane32_swap_b32 v117, v115
v_add_f32 v115, v115, v117
v_smfmac_f32_16x16x64_bf16 v[104:107], v[84:87], v[248:255], v126
L_att_2:
ds_write_b128 v14, v[92:95] offset:0
ds_write_b128 v14, v[96:99] offset:512
s_mov_b64 exec, 0x101
ds_write_b64 v15, v[112:113]
ds_write_b64 v15, v[114:115] offset:64
s_mov_b64 exec, -1
ds_write_b128 v14, v[100:103] offset:2048
s_nop 0
ds_write_b128 v14, v[104:107] offset:2560
s_waitcnt lgkmcnt(0)
s_barrier
ds_read_b128 v[48:51], v17
ds_read_b128 v[52:55], v17 offset:16
ds_read_b128 v[32:35], v16 offset:0
ds_read_b128 v[36:39], v16 offset:4096
ds_read_b128 v[40:43], v16 offset:8192
ds_read_b128 v[44:47], v16 offset:12288
s_waitcnt lgkmcnt(4)
v_max3_f32 v56, v48, v50, v52
v_max_f32 v56, v56, v54
v_sub_f32 v48, v48, v56
v_sub_f32 v50, v50, v56
v_sub_f32 v52, v52, v56
v_sub_f32 v54, v54, v56
v_exp_f32 v48, v48
v_exp_f32 v50, v50
v_exp_f32 v52, v52
v_exp_f32 v54, v54
v_mul_f32 v57, v48, v49
v_fmac_f32 v57, v50, v51
v_fmac_f32 v57, v52, v53
v_fmac_f32 v57, v54, v55
v_rcp_f32 v58, v57
v_log_f32 v59, v57
s_waitcnt lgkmcnt(0)
v_pk_mul_f32 v[60:61], v[32:33], v[48:49] op_sel_hi:[1,0]
v_pk_mul_f32 v[62:63], v[34:35], v[48:49] op_sel_hi:[1,0]
v_add_f32 v59, v59, v56
v_pk_fma_f32 v[60:61], v[36:37], v[50:51], v[60:61] op_sel_hi:[1,0,1]
v_pk_fma_f32 v[62:63], v[38:39], v[50:51], v[62:63] op_sel_hi:[1,0,1]
v_pk_fma_f32 v[60:61], v[40:41], v[52:53], v[60:61] op_sel_hi:[1,0,1]
v_pk_fma_f32 v[62:63], v[42:43], v[52:53], v[62:63] op_sel_hi:[1,0,1]
v_pk_fma_f32 v[60:61], v[44:45], v[54:55], v[60:61] op_sel_hi:[1,0,1]
v_pk_fma_f32 v[62:63], v[46:47], v[54:55], v[62:63] op_sel_hi:[1,0,1]
v_min_u32 v59, -2, v59
v_pk_mul_f32 v[60:61], v[60:61], v[58:59] op_sel_hi:[1,0]
v_pk_mul_f32 v[62:63], v[62:63], v[58:59] op_sel_hi:[1,0]
v_cvt_pk_bf16_f32 v64, v60, v61
v_cvt_pk_bf16_f32 v65, v62, v63
v_min_u32 v64, -2, v64
v_min_u32 v65, -2, v65
s_cmp_lg_u32 s101, 0
s_cbranch_scc0 L_gs8
buffer_store_dwordx2 v[64:65], v3, s[52:55], s84 offen
s_mov_b64 exec, 1
buffer_store_dword v59, v6, s[52:55], s85 offen
s_mov_b64 exec, -1
L_gsb8:
s_cmp_lg_u32 s23, 0
s_cbranch_scc1 L_q_2
s_mov_b32 s88, 0
L_g1p_2:
buffer_load_dwordx4 v[64:67], v5, s[52:55], s79 offen sc1
buffer_load_dwordx4 v[68:71], v5, s[52:55], s79 offen offset:16 sc1
s_waitcnt vmcnt(0)
v_max3_u32 v79, v64, v65, v66
v_max3_u32 v78, v67, v68, v69
v_max3_u32 v79, v79, v70, v71
v_max_u32 v79, v79, v78
v_cmp_eq_u32 vcc, -1, v79
s_cbranch_vccz L_g1px_2
s_add_u32 s88, s88, 1
s_cmp_lt_u32 s88, 200000
s_cbranch_scc1 L_g1p_2
L_g1px_2:
buffer_load_dwordx4 v[32:35], v4, s[52:55], s81 offen offset:0 sc1
buffer_load_dwordx4 v[36:39], v4, s[52:55], s81 offen offset:1024 sc1
buffer_load_dwordx4 v[40:43], v4, s[52:55], s81 offen offset:2048 sc1
buffer_load_dwordx4 v[44:47], v4, s[52:55], s81 offen offset:3072 sc1
buffer_load_dwordx4 v[48:51], v4, s[52:55], s82 offen offset:0 sc1
buffer_load_dwordx4 v[52:55], v4, s[52:55], s82 offen offset:1024 sc1
buffer_load_dwordx4 v[56:59], v4, s[52:55], s82 offen offset:2048 sc1
buffer_load_dwordx4 v[60:63], v4, s[52:55], s82 offen offset:3072 sc1
v_mov_b32 v76, v122
v_mov_b32 v77, v123
v_mov_b32 v78, v124
v_mov_b32 v90, v125
v_mov_b32 v91, v126
ds_read_b64_tr_b16 v[96:97], v20 offset:0
ds_read_b64_tr_b16 v[98:99], v20 offset:128
ds_read_b64_tr_b16 v[100:101], v20 offset:1024
ds_read_b64_tr_b16 v[102:103], v20 offset:1152
ds_read_b64_tr_b16 v[104:105], v20 offset:2048
ds_read_b64_tr_b16 v[106:107], v20 offset:2176
ds_read_b64_tr_b16 v[108:109], v20 offset:3072
ds_read_b64_tr_b16 v[110:111], v20 offset:3200
ds_read_b64_tr_b16 v[112:113], v20 offset:4096
ds_read_b64_tr_b16 v[114:115], v20 offset:4224
ds_read_b64_tr_b16 v[116:117], v20 offset:5120
ds_read_b64_tr_b16 v[118:119], v20 offset:5248
s_waitcnt lgkmcnt(6)
ds_read_b64_tr_b16 v[120:121], v20 offset:6144
ds_read_b64_tr_b16 v[122:123], v20 offset:6272
ds_read_b64_tr_b16 v[124:125], v20 offset:7168
ds_read_b64_tr_b16 v[126:127], v20 offset:7296
L_g1c_2:
v_max3_f32 v72, v64, v65, v66
v_max3_f32 v73, v67, v68, v69
v_max3_f32 v72, v72, v70, v71
v_max_f32 v72, v72, v73
v_mov_b32 v73, v72
s_nop 1
v_permlane16_swap_b32 v73, v72
v_max_f32 v72, v72, v73
v_mov_b32 v73, v72
s_nop 1
v_permlane32_swap_b32 v73, v72
v_max_f32 v72, v72, v73
v_sub_f32 v64, v64, v72
v_sub_f32 v65, v65, v72
v_sub_f32 v66, v66, v72
v_sub_f32 v67, v67, v72
v_sub_f32 v68, v68, v72
v_sub_f32 v69, v69, v72
v_sub_f32 v70, v70, v72
v_sub_f32 v71, v71, v72
v_exp_f32 v64, v64
v_exp_f32 v65, v65
v_exp_f32 v66, v66
v_exp_f32 v67, v67
v_exp_f32 v68, v68
v_exp_f32 v69, v69
v_exp_f32 v70, v70
v_exp_f32 v71, v71
v_mov_b64 v[92:93], 0
v_mov_b64 v[94:95], 0
v_cvt_pk_bf16_f32 v88, v64, v65
v_cvt_pk_bf16_f32 v89, v66, v67
v_and_b32 v80, v88, v76
v_and_b32 v81, v88, v77
v_and_b32 v82, v88, v78
v_and_b32 v83, v88, v90
v_and_b32 v84, v89, v76
v_and_b32 v85, v89, v77
v_and_b32 v86, v89, v78
v_and_b32 v87, v89, v90
v_add_f32 v74, v64, v65
v_add_f32 v75, v66, v67
s_waitcnt vmcnt(0)
v_smfmac_f32_16x16x64_bf16 v[92:95], v[80:83], v[32:39], v91
v_cvt_pk_bf16_f32 v88, v68, v69
v_and_b32 v80, v88, v76
v_and_b32 v81, v88, v77
v_and_b32 v82, v88, v78
v_and_b32 v83, v88, v90
v_add_f32 v74, v74, v75
v_add_f32 v75, v68, v69
v_smfmac_f32_16x16x64_bf16 v[92:95], v[84:87], v[40:47], v91
v_cvt_pk_bf16_f32 v89, v70, v71
v_and_b32 v84, v89, v76
v_and_b32 v85, v89, v77
v_and_b32 v86, v89, v78
v_and_b32 v87, v89, v90
v_add_f32 v73, v70, v71
v_add_f32 v75, v75, v73
v_smfmac_f32_16x16x64_bf16 v[92:95], v[80:83], v[48:55], v91
v_add_f32 v74, v74, v75
v_mov_b32 v73, v74
s_nop 1
v_permlane16_swap_b32 v73, v74
v_add_f32 v74, v74, v73
v_smfmac_f32_16x16x64_bf16 v[92:95], v[84:87], v[56:63], v91
v_mov_b32 v73, v74
s_nop 1
v_permlane32_swap_b32 v73, v74
v_add_f32 v74, v74, v73
v_rcp_f32 v74, v74
s_nop 1
v_mul_f32 v92, v92, v74
v_mul_f32 v93, v93, v74
v_mul_f32 v94, v94, v74
v_mul_f32 v95, v95, v74
v_add_f32 v72, v92, v93
v_add_f32 v73, v94, v95
v_add_f32 v72, v72, v73
v_cmp_u_f32 vcc, v72, v72
s_cbranch_vccnz L_g1r_2
L_g1ok_2:
s_mov_b32 s89, 0
v_cvt_pk_bf16_f32 v76, v92, v93
v_cvt_pk_bf16_f32 v77, v94, v95
ds_write_b64 v18, v[76:77]
s_waitcnt lgkmcnt(0)
s_barrier
ds_read_b128 v[32:35], v19 offset:0
ds_read_b128 v[36:39], v19 offset:64
ds_read_b128 v[40:43], v19 offset:128
ds_read_b128 v[44:47], v19 offset:192
ds_read_b128 v[48:51], v19 offset:256
ds_read_b128 v[52:55], v19 offset:320
ds_read_b128 v[56:59], v19 offset:384
ds_read_b128 v[60:63], v19 offset:448
s_waitcnt lgkmcnt(7)
v_mfma_f32_16x16x32_bf16 v[92:95], v[96:99], v[32:35], 0
s_waitcnt lgkmcnt(6)
v_mfma_f32_16x16x32_bf16 v[92:95], v[100:103], v[36:39], v[92:95]
s_waitcnt lgkmcnt(5)
v_mfma_f32_16x16x32_bf16 v[92:95], v[104:107], v[40:43], v[92:95]
s_waitcnt lgkmcnt(4)
v_mfma_f32_16x16x32_bf16 v[92:95], v[108:111], v[44:47], v[92:95]
s_waitcnt lgkmcnt(3)
v_mfma_f32_16x16x32_bf16 v[92:95], v[112:115], v[48:51], v[92:95]
s_waitcnt lgkmcnt(2)
v_mfma_f32_16x16x32_bf16 v[92:95], v[116:119], v[52:55], v[92:95]
s_waitcnt lgkmcnt(1)
v_mfma_f32_16x16x32_bf16 v[92:95], v[120:123], v[56:59], v[92:95]
s_waitcnt lgkmcnt(0)
v_mfma_f32_16x16x32_bf16 v[92:95], v[124:127], v[60:63], v[92:95]
s_mov_b32 exec_lo, 0x00030003
s_cmp_eq_u32 s65, 3
s_cselect_b32 exec_hi, 0, 0x00030003
s_nop 4
v_cvt_pk_bf16_f32 v76, v92, v93
v_cvt_pk_bf16_f32 v77, v94, v95
v_min_u32 v76, -2, v76
v_min_u32 v77, -2, v77
buffer_store_dwordx2 v[76:77], v7, s[52:55], s80 offen sc1
s_mov_b64 exec, -1
s_cmp_eq_u32 s65, 0
s_cbranch_scc0 L_nof2_2
v_mov_b32 v78, s14
s_lshl_b32 s90, s66, 2
v_mov_b32 v79, s90
s_mov_b64 exec, 1
buffer_store_dword v78, v79, s[52:55], s17 offen sc1
s_mov_b64 exec, -1
L_nof2_2:
s_barrier
buffer_load_dwordx4 a[28:31], v1, s[44:47], s68 offen offset:896 nt
buffer_load_dwordx4 a[32:35], v1, s[44:47], s69 offen offset:0 nt
buffer_load_dwordx4 a[36:39], v1, s[44:47], s69 offen offset:128 nt
buffer_load_dwordx4 a[40:43], v1, s[44:47], s69 offen offset:256 nt
buffer_load_dwordx4 a[44:47], v1, s[44:47], s69 offen offset:384 nt
buffer_load_dwordx4 a[48:51], v1, s[44:47], s69 offen offset:512 nt
buffer_load_dwordx4 a[52:55], v1, s[44:47], s69 offen offset:640 nt
buffer_load_dwordx4 a[56:59], v1, s[44:47], s69 offen offset:768 nt
buffer_load_dwordx4 a[60:63], v1, s[44:47], s69 offen offset:896 nt
buffer_load_dwordx4 a[64:67], v2, s[48:51], s68 offen offset:0 nt
buffer_load_dwordx4 a[68:71], v2, s[48:51], s68 offen offset:2048 nt
buffer_load_dwordx4 a[72:75], v2, s[48:51], s68 offen offset:256 nt
buffer_load_dwordx4 a[76:79], v2, s[48:51], s68 offen offset:2304 nt
buffer_load_dwordx4 a[80:83], v2, s[48:51], s68 offen offset:1024 nt
buffer_load_dwordx4 a[84:87], v2, s[48:51], s68 offen offset:3072 nt
buffer_load_dwordx4 a[88:91], v2, s[48:51], s68 offen offset:1280 nt
buffer_load_dwordx4 a[92:95], v2, s[48:51], s68 offen offset:3328 nt
buffer_load_dwordx4 a[96:99], v2, s[48:51], s69 offen offset:0 nt
buffer_load_dwordx4 a[100:103], v2, s[48:51], s69 offen offset:2048 nt
buffer_load_dwordx4 a[104:107], v2, s[48:51], s69 offen offset:256 nt
buffer_load_dwordx4 a[108:111], v2, s[48:51], s69 offen offset:2304 nt
buffer_load_dwordx4 a[112:115], v2, s[48:51], s69 offen offset:1024 nt
buffer_load_dwordx4 a[116:119], v2, s[48:51], s69 offen offset:3072 nt
buffer_load_dwordx4 a[120:123], v2, s[48:51], s69 offen offset:1280 nt
buffer_load_dwordx4 a[124:127], v2, s[48:51], s69 offen offset:3328 nt
s_branch L_e_2
L_q_2:
s_barrier
buffer_load_dwordx4 a[28:31], v1, s[44:47], s68 offen offset:896 nt
buffer_load_dwordx4 a[32:35], v1, s[44:47], s69 offen offset:0 nt
buffer_load_dwordx4 a[36:39], v1, s[44:47], s69 offen offset:128 nt
buffer_load_dwordx4 a[40:43], v1, s[44:47], s69 offen offset:256 nt
buffer_load_dwordx4 a[44:47], v1, s[44:47], s69 offen offset:384 nt
buffer_load_dwordx4 a[48:51], v1, s[44:47], s69 offen offset:512 nt
buffer_load_dwordx4 a[52:55], v1, s[44:47], s69 offen offset:640 nt
buffer_load_dwordx4 a[56:59], v1, s[44:47], s69 offen offset:768 nt
buffer_load_dwordx4 a[60:63], v1, s[44:47], s69 offen offset:896 nt
buffer_load_dwordx4 a[64:67], v2, s[48:51], s68 offen offset:0 nt
buffer_load_dwordx4 a[68:71], v2, s[48:51], s68 offen offset:2048 nt
buffer_load_dwordx4 a[72:75], v2, s[48:51], s68 offen offset:256 nt
buffer_load_dwordx4 a[76:79], v2, s[48:51], s68 offen offset:2304 nt
buffer_load_dwordx4 a[80:83], v2, s[48:51], s68 offen offset:1024 nt
buffer_load_dwordx4 a[84:87], v2, s[48:51], s68 offen offset:3072 nt
buffer_load_dwordx4 a[88:91], v2, s[48:51], s68 offen offset:1280 nt
buffer_load_dwordx4 a[92:95], v2, s[48:51], s68 offen offset:3328 nt
buffer_load_dwordx4 a[96:99], v2, s[48:51], s69 offen offset:0 nt
buffer_load_dwordx4 a[100:103], v2, s[48:51], s69 offen offset:2048 nt
s_cmp_lg_u32 s65, 2
s_cbranch_scc1 L_nop2_2
s_mov_b32 s88, 0
L_hp_2_2:
s_load_dwordx8 s[4:11], s[40:41], s17 glc
s_waitcnt lgkmcnt(0)
s_xor_b64 s[4:5], s[4:5], s[14:15]
s_xor_b64 s[6:7], s[6:7], s[14:15]
s_xor_b64 s[8:9], s[8:9], s[14:15]
s_xor_b64 s[10:11], s[10:11], s[14:15]
s_or_b64 s[4:5], s[4:5], s[6:7]
s_or_b64 s[8:9], s[8:9], s[10:11]
s_or_b64 s[4:5], s[4:5], s[8:9]
s_cbranch_scc0 L_hpx_2_2
s_add_u32 s88, s88, 1
s_cmp_lt_u32 s88, 400
s_cbranch_scc1 L_hp_2_2
L_hpx_2_2:
L_nop2_2:
s_barrier
v_subrev_u32 v92, 98304, v23
v_subrev_u32 v93, 98304, v24
buffer_load_dwordx4 v[32:35], v8, s[52:55], s80 offen offset:0
buffer_load_dwordx4 v[36:39], v8, s[52:55], s80 offen offset:1024
buffer_load_dwordx4 v[40:43], v8, s[52:55], s80 offen offset:2048
buffer_load_dwordx4 v[44:47], v8, s[52:55], s80 offen offset:3072
buffer_load_dwordx4 v[48:51], v9, s[52:55], s80 offen offset:0
buffer_load_dwordx4 v[52:55], v9, s[52:55], s80 offen offset:1024
buffer_load_dwordx4 v[56:59], v9, s[52:55], s80 offen offset:2048
buffer_load_dwordx4 v[60:63], v9, s[52:55], s80 offen offset:3072
buffer_load_dwordx2 v[84:85], v92, s[60:63], s24 offen
buffer_load_dwordx2 v[88:89], v93, s[60:63], s24 offen
s_barrier
buffer_load_dwordx4 a[104:107], v2, s[48:51], s69 offen offset:256 nt
buffer_load_dwordx4 a[108:111], v2, s[48:51], s69 offen offset:2304 nt
buffer_load_dwordx4 a[112:115], v2, s[48:51], s69 offen offset:1024 nt
buffer_load_dwordx4 a[116:119], v2, s[48:51], s69 offen offset:3072 nt
buffer_load_dwordx4 a[120:123], v2, s[48:51], s69 offen offset:1280 nt
buffer_load_dwordx4 a[124:127], v2, s[48:51], s69 offen offset:3328 nt
v_mov_b32 v94, 0x3f803f80
v_and_b32 v80, v94, v122
v_and_b32 v81, v94, v123
v_and_b32 v82, v94, v124
v_and_b32 v83, v94, v125
v_mov_b32 v90, v126
v_subrev_u32 v76, 98304, v23
v_subrev_u32 v76, s71, v76
v_subrev_u32 v77, 98304, v24
v_subrev_u32 v77, s71, v77
v_min_u32 v78, 0x378, v76
v_add_u32 v78, s72, v78
v_min_u32 v79, 0x378, v77
v_add_u32 v79, s72, v79
ds_read_b64 v[72:73], v78
ds_read_b64 v[74:75], v79
s_cmp_gt_u32 s65, 1
s_cbranch_scc1 L_nowq_2
ds_read_b64_tr_b16 v[96:97], v21 offset:0
ds_read_b64_tr_b16 v[98:99], v21 offset:128
ds_read_b64_tr_b16 v[100:101], v21 offset:1024
ds_read_b64_tr_b16 v[102:103], v21 offset:1152
ds_read_b64_tr_b16 v[104:105], v21 offset:2048
ds_read_b64_tr_b16 v[106:107], v21 offset:2176
ds_read_b64_tr_b16 v[108:109], v21 offset:3072
ds_read_b64_tr_b16 v[110:111], v21 offset:3200
ds_read_b64_tr_b16 v[112:113], v21 offset:4096
ds_read_b64_tr_b16 v[114:115], v21 offset:4224
ds_read_b64_tr_b16 v[116:117], v21 offset:5120
ds_read_b64_tr_b16 v[118:119], v21 offset:5248
s_waitcnt lgkmcnt(6)
ds_read_b64_tr_b16 v[120:121], v21 offset:6144
ds_read_b64_tr_b16 v[122:123], v21 offset:6272
ds_read_b64_tr_b16 v[124:125], v21 offset:7168
ds_read_b64_tr_b16 v[126:127], v21 offset:7296
L_nowq_2:
s_waitcnt vmcnt(6)
L_g2c_2:
v_lshlrev_b32 v64, 16, v84
v_and_b32 v65, 0xffff0000, v84
v_lshlrev_b32 v66, 16, v85
v_and_b32 v67, 0xffff0000, v85
v_lshlrev_b32 v68, 16, v88
v_and_b32 v69, 0xffff0000, v88
v_lshlrev_b32 v70, 16, v89
v_and_b32 v71, 0xffff0000, v89
v_smfmac_f32_16x16x64_bf16 v[64:67], v[80:83], v[32:39], v90
s_nop 0
v_smfmac_f32_16x16x64_bf16 v[68:71], v[80:83], v[48:55], v90
v_smfmac_f32_16x16x64_bf16 v[64:67], v[80:83], v[40:47], v90
v_smfmac_f32_16x16x64_bf16 v[68:71], v[80:83], v[56:63], v90
s_nop 6
v_add_f32 v92, v64, v65
v_add_f32 v93, v66, v67
v_add_f32 v94, v68, v69
v_add_f32 v95, v70, v71
v_add_f32 v92, v92, v93
v_add_f32 v94, v94, v95
v_add_f32 v92, v92, v94
v_cmp_u_f32 vcc, v92, v92
s_cbranch_vccnz L_g2r_2
L_g2ok_2:
s_mov_b32 s89, 0
v_cvt_pk_bf16_f32 v64, v64, v65
v_cvt_pk_bf16_f32 v65, v66, v67
v_cvt_pk_bf16_f32 v66, v68, v69
v_cvt_pk_bf16_f32 v67, v70, v71
s_waitcnt lgkmcnt(0)
s_cmp_eq_u32 s70, 0
s_cbranch_scc1 L_xw_2
s_movk_i32 s90, 896
v_cmp_gt_u32 vcc, s90, v76
s_cmp_eq_u32 s74, 0
s_cselect_b32 s91, 1, 0
s_cmp_ge_u32 s64, 2
s_cselect_b32 s91, s91, 0
s_cmp_eq_u32 s91, 0
s_cbranch_scc1 L_noout_2
s_and_b64 s[92:93], vcc, exec
s_mov_b32 s93, 0
s_mov_b64 exec, s[92:93]
buffer_store_dwordx2 v[64:65], v76, s[56:59], s73 offen
s_mov_b64 exec, -1
s_movk_i32 s90, 896
v_cmp_gt_u32 s[92:93], s90, v77
s_mov_b32 s93, 0
s_mov_b64 exec, s[92:93]
buffer_store_dwordx2 v[66:67], v77, s[56:59], s73 offen
s_mov_b64 exec, -1
L_noout_2:
s_movk_i32 s90, 896
v_cmp_gt_u32 vcc, s90, v76
s_nop 1
v_cndmask_b32 v64, v64, v72, vcc
v_cndmask_b32 v65, v65, v73, vcc
v_cmp_gt_u32 vcc, s90, v77
s_nop 1
v_cndmask_b32 v66, v66, v74, vcc
v_cndmask_b32 v67, v67, v75, vcc
L_xw_2:
ds_write_b64 v23, v[64:65]
ds_write_b64 v24, v[66:67]
s_cmp_lg_u32 s66, 0
s_cbranch_scc1 L_noxs_2
s_cmp_lg_u32 s27, 0
s_cbranch_scc1 L_noxs_2
v_min_u32 v68, -2, v64
v_min_u32 v69, -2, v65
v_min_u32 v70, -2, v66
v_min_u32 v71, -2, v67
v_subrev_u32 v92, 98304, v23
v_subrev_u32 v93, 98304, v24
s_mov_b32 exec_hi, 0
buffer_store_dwordx2 v[68:69], v92, s[52:55], s25 offen sc1
buffer_store_dwordx2 v[70:71], v93, s[52:55], s25 offen sc1
s_mov_b32 exec_hi, -1
L_noxs_2:
s_cmp_eq_u32 s64, 17
s_cbranch_scc1 L_e_2
L_qp_2:
s_mov_b32 s76, 45056
s_mov_b32 s42, 61440
s_waitcnt lgkmcnt(0)
s_barrier
s_cmp_gt_u32 s65, 1
s_cbranch_scc1 L_e_2
ds_read_b128 v[32:35], v22 offset:0
ds_read_b128 v[36:39], v22 offset:64
ds_read_b128 v[40:43], v22 offset:128
ds_read_b128 v[44:47], v22 offset:192
ds_read_b128 v[48:51], v22 offset:256
ds_read_b128 v[52:55], v22 offset:320
ds_read_b128 v[56:59], v22 offset:384
ds_read_b128 v[60:63], v22 offset:448
ds_read_b128 v[64:67], v22 offset:512
ds_read_b128 v[68:71], v22 offset:576
ds_read_b128 v[72:75], v22 offset:640
ds_read_b128 v[76:79], v22 offset:704
ds_read_b128 v[80:83], v22 offset:768
ds_read_b128 v[84:87], v22 offset:832
s_waitcnt lgkmcnt(7)
v_mfma_f32_16x16x32_bf16 v[92:95], v[96:99], v[32:35], 0
v_mfma_f32_16x16x32_bf16 v[88:91], v[32:35], v[32:35], 0
ds_read_b64_tr_b16 v[96:97], v21 offset:8192
ds_read_b64_tr_b16 v[98:99], v21 offset:8320
v_mfma_f32_16x16x32_bf16 v[92:95], v[100:103], v[36:39], v[92:95]
v_mfma_f32_16x16x32_bf16 v[88:91], v[36:39], v[36:39], v[88:91]
ds_read_b64_tr_b16 v[100:101], v21 offset:9216
ds_read_b64_tr_b16 v[102:103], v21 offset:9344
v_mfma_f32_16x16x32_bf16 v[92:95], v[104:107], v[40:43], v[92:95]
v_mfma_f32_16x16x32_bf16 v[88:91], v[40:43], v[40:43], v[88:91]
ds_read_b64_tr_b16 v[104:105], v21 offset:10240
ds_read_b64_tr_b16 v[106:107], v21 offset:10368
v_mfma_f32_16x16x32_bf16 v[92:95], v[108:111], v[44:47], v[92:95]
v_mfma_f32_16x16x32_bf16 v[88:91], v[44:47], v[44:47], v[88:91]
ds_read_b64_tr_b16 v[108:109], v21 offset:11264
ds_read_b64_tr_b16 v[110:111], v21 offset:11392
s_waitcnt lgkmcnt(8)
v_mfma_f32_16x16x32_bf16 v[92:95], v[112:115], v[48:51], v[92:95]
v_mfma_f32_16x16x32_bf16 v[88:91], v[48:51], v[48:51], v[88:91]
ds_read_b64_tr_b16 v[112:113], v21 offset:12288
ds_read_b64_tr_b16 v[114:115], v21 offset:12416
v_mfma_f32_16x16x32_bf16 v[92:95], v[116:119], v[52:55], v[92:95]
v_mfma_f32_16x16x32_bf16 v[88:91], v[52:55], v[52:55], v[88:91]
ds_read_b64_tr_b16 v[116:117], v21 offset:13312
ds_read_b64_tr_b16 v[118:119], v21 offset:13440
v_mfma_f32_16x16x32_bf16 v[92:95], v[120:123], v[56:59], v[92:95]
v_mfma_f32_16x16x32_bf16 v[88:91], v[56:59], v[56:59], v[88:91]
v_mfma_f32_16x16x32_bf16 v[92:95], v[124:127], v[60:63], v[92:95]
v_mfma_f32_16x16x32_bf16 v[88:91], v[60:63], v[60:63], v[88:91]
s_waitcnt lgkmcnt(10)
v_mfma_f32_16x16x32_bf16 v[92:95], v[96:99], v[64:67], v[92:95]
v_mfma_f32_16x16x32_bf16 v[88:91], v[64:67], v[64:67], v[88:91]
s_waitcnt lgkmcnt(8)
v_mfma_f32_16x16x32_bf16 v[92:95], v[100:103], v[68:71], v[92:95]
v_mfma_f32_16x16x32_bf16 v[88:91], v[68:71], v[68:71], v[88:91]
s_waitcnt lgkmcnt(6)
v_mfma_f32_16x16x32_bf16 v[92:95], v[104:107], v[72:75], v[92:95]
v_mfma_f32_16x16x32_bf16 v[88:91], v[72:75], v[72:75], v[88:91]
s_waitcnt lgkmcnt(4)
v_mfma_f32_16x16x32_bf16 v[92:95], v[108:111], v[76:79], v[92:95]
v_mfma_f32_16x16x32_bf16 v[88:91], v[76:79], v[76:79], v[88:91]
s_waitcnt lgkmcnt(2)
v_mfma_f32_16x16x32_bf16 v[92:95], v[112:115], v[80:83], v[92:95]
v_mfma_f32_16x16x32_bf16 v[88:91], v[80:83], v[80:83], v[88:91]
s_waitcnt lgkmcnt(0)
v_mfma_f32_16x16x32_bf16 v[92:95], v[116:119], v[84:87], v[92:95]
v_mfma_f32_16x16x32_bf16 v[88:91], v[84:87], v[84:87], v[88:91]
v_and_b32 v32, 1, v0
v_cmp_eq_u32 vcc, 1, v32
v_mov_b32 v34, 0x3b124925
s_nop 4
v_cndmask_b32 v33, v88, v89, vcc
v_mul_f32 v35, v90, v34
v_mul_f32 v33, v33, v34
v_fma_f32 v33, -v35, v35, v33
v_max_f32 v33, 0, v33
v_add_f32 v33, 0x3727c5ac, v33
v_rsq_f32 v33, v33
v_sub_f32 v35, 0, v35
s_nop 1
v_fmac_f32_dpp v92, v92, v35 row_shl:2 row_mask:0xf bank_mask:0xf
v_fmac_f32_dpp v93, v93, v35 row_shl:2 row_mask:0xf bank_mask:0xf
v_fmac_f32_dpp v94, v94, v35 row_shl:2 row_mask:0xf bank_mask:0xf
v_fmac_f32_dpp v95, v95, v35 row_shl:2 row_mask:0xf bank_mask:0xf
v_mul_f32 v92, v92, v33
v_mul_f32 v93, v93, v33
v_mul_f32 v94, v94, v33
v_mul_f32 v95, v95, v33
v_mov_b32 v40, -1
v_mov_b32 v41, -1
v_cvt_pk_bf16_f32 v36, v92, v93
v_cvt_pk_bf16_f32 v37, v94, v95
v_min_u32 v36, -2, v36
v_min_u32 v37, -2, v37
s_mov_b32 exec_lo, 0x00030003
s_mov_b32 exec_hi, 0x00030003
s_cmp_lg_u32 s101, 0
s_cbranch_scc0 L_gs9
buffer_store_dwordx2 v[36:37], v10, s[52:55], s76 offen
buffer_store_dwordx2 v[40:41], v10, s[52:55], s42 offen
L_gsb9:
s_mov_b64 exec, -1
L_e_2:
s_add_u32 s64, s64, 1
s_cmp_eq_u32 s64, 0
s_cbranch_scc1 L_top0
s_add_u32 s14, s14, 0x01010101
s_mov_b32 s15, s14
s_mov_b32 s60, s40
s_mov_b32 s61, s41
s_mov_b32 s62, 67108864
s_lshl_b32 s91, s64, 11
s_add_u32 s24, s91, 622592
s_cmp_ge_u32 s64, 18
s_cbranch_scc1 L_end
s_branch L_top0
L_end:
s_endpgm
L_gs1:
buffer_store_dwordx2 v[120:121], v3, s[52:55], s83 offen sc1
s_mov_b64 exec, 1
buffer_store_dword v120, v6, s[52:55], s43 offen sc1
s_mov_b64 exec, -1
s_branch L_gsb1
L_gs2:
buffer_store_dwordx2 v[64:65], v3, s[52:55], s84 offen sc1
s_mov_b64 exec, 1
buffer_store_dword v59, v6, s[52:55], s85 offen sc1
s_mov_b64 exec, -1
s_branch L_gsb2
L_g1r_0:
s_cmp_lg_u32 s89, 0
s_cbranch_scc1 L_g1ok_0
s_mov_b32 s88, 0
L_g1rl_0:
buffer_load_dwordx4 v[32:35], v4, s[52:55], s81 offen offset:0 sc1
buffer_load_dwordx4 v[36:39], v4, s[52:55], s81 offen offset:1024 sc1
buffer_load_dwordx4 v[40:43], v4, s[52:55], s81 offen offset:2048 sc1
buffer_load_dwordx4 v[44:47], v4, s[52:55], s81 offen offset:3072 sc1
buffer_load_dwordx4 v[48:51], v4, s[52:55], s82 offen offset:0 sc1
buffer_load_dwordx4 v[52:55], v4, s[52:55], s82 offen offset:1024 sc1
buffer_load_dwordx4 v[56:59], v4, s[52:55], s82 offen offset:2048 sc1
buffer_load_dwordx4 v[60:63], v4, s[52:55], s82 offen offset:3072 sc1
buffer_load_dwordx4 v[64:67], v5, s[52:55], s79 offen sc1
buffer_load_dwordx4 v[68:71], v5, s[52:55], s79 offen offset:16 sc1
s_waitcnt vmcnt(0)
v_max3_u32 v79, v32, v33, v34
v_max3_u32 v79, v79, v35, v36
v_max3_u32 v79, v79, v37, v38
v_max3_u32 v79, v79, v39, v40
v_max3_u32 v79, v79, v41, v42
v_max3_u32 v79, v79, v43, v44
v_max3_u32 v79, v79, v45, v46
v_max3_u32 v79, v79, v47, v48
v_max3_u32 v79, v79, v49, v50
v_max3_u32 v79, v79, v51, v52
v_max3_u32 v79, v79, v53, v54
v_max3_u32 v79, v79, v55, v56
v_max3_u32 v79, v79, v57, v58
v_max3_u32 v79, v79, v59, v60
v_max3_u32 v79, v79, v61, v62
v_max3_u32 v79, v79, v63, v64
v_max3_u32 v79, v79, v65, v66
v_max3_u32 v79, v79, v67, v68
v_max3_u32 v79, v79, v69, v70
v_max_u32 v79, v79, v71
v_cmp_eq_u32 vcc, -1, v79
s_mov_b32 s89, 1
s_cbranch_vccz L_g1c_0
s_add_u32 s88, s88, 1
s_cmp_lt_u32 s88, 200000
s_cbranch_scc1 L_g1rl_0
s_branch L_g1c_0
L_g2r_0:
s_cmp_lg_u32 s89, 0
s_cbranch_scc1 L_g2ok_0
s_mov_b32 s88, 0
L_g2rl_0:
v_subrev_u32 v92, 98304, v23
v_subrev_u32 v93, 98304, v24
buffer_load_dwordx4 v[32:35], v8, s[52:55], s80 offen offset:0 sc1
buffer_load_dwordx4 v[36:39], v8, s[52:55], s80 offen offset:1024 sc1
buffer_load_dwordx4 v[40:43], v8, s[52:55], s80 offen offset:2048 sc1
buffer_load_dwordx4 v[44:47], v8, s[52:55], s80 offen offset:3072 sc1
buffer_load_dwordx4 v[48:51], v9, s[52:55], s80 offen offset:0 sc1
buffer_load_dwordx4 v[52:55], v9, s[52:55], s80 offen offset:1024 sc1
buffer_load_dwordx4 v[56:59], v9, s[52:55], s80 offen offset:2048 sc1
buffer_load_dwordx4 v[60:63], v9, s[52:55], s80 offen offset:3072 sc1
buffer_load_dwordx2 v[84:85], v92, s[60:63], s24 offen sc1
buffer_load_dwordx2 v[88:89], v93, s[60:63], s24 offen sc1
s_waitcnt vmcnt(0)
v_max3_u32 v79, v32, v33, v34
v_max3_u32 v79, v79, v35, v36
v_max3_u32 v79, v79, v37, v38
v_max3_u32 v79, v79, v39, v40
v_max3_u32 v79, v79, v41, v42
v_max3_u32 v79, v79, v43, v44
v_max3_u32 v79, v79, v45, v46
v_max3_u32 v79, v79, v47, v48
v_max3_u32 v79, v79, v49, v50
v_max3_u32 v79, v79, v51, v52
v_max3_u32 v79, v79, v53, v54
v_max3_u32 v79, v79, v55, v56
v_max3_u32 v79, v79, v57, v58
v_max3_u32 v79, v79, v59, v60
v_max3_u32 v79, v79, v61, v62
v_max3_u32 v79, v79, v63, v84
v_max3_u32 v79, v79, v85, v88
v_max_u32 v79, v79, v89
v_cmp_eq_u32 vcc, -1, v79
s_mov_b32 s89, 1
s_cbranch_vccz L_g2c_0
s_add_u32 s88, s88, 1
s_cmp_lt_u32 s88, 200000
s_cbranch_scc1 L_g2rl_0
s_branch L_g2c_0
L_gs3:
buffer_store_dwordx2 v[36:37], v10, s[52:55], s76 offen sc1
buffer_store_dwordx2 v[40:41], v10, s[52:55], s42 offen sc1
s_branch L_gsb3
L_gs4:
buffer_store_dwordx2 v[120:121], v3, s[52:55], s83 offen sc1
s_mov_b64 exec, 1
buffer_store_dword v120, v6, s[52:55], s43 offen sc1
s_mov_b64 exec, -1
s_branch L_gsb4
L_oo_1:
s_waitcnt lgkmcnt(7)
v_mfma_f32_16x16x32_bf16 v[80:83], v[128:131], v[32:35], 0
v_mfma_f32_16x16x32_bf16 v[84:87], v[144:147], v[32:35], 0
v_mfma_f32_16x16x32_bf16 v[88:91], v[160:163], v[32:35], 0
v_mfma_f32_16x16x32_bf16 v[92:95], v[176:179], v[32:35], 0
s_waitcnt lgkmcnt(6)
v_mfma_f32_16x16x32_bf16 v[80:83], v[132:135], v[36:39], v[80:83]
v_mfma_f32_16x16x32_bf16 v[84:87], v[148:151], v[36:39], v[84:87]
v_mfma_f32_16x16x32_bf16 v[88:91], v[164:167], v[36:39], v[88:91]
v_mfma_f32_16x16x32_bf16 v[92:95], v[180:183], v[36:39], v[92:95]
s_waitcnt lgkmcnt(5)
v_mfma_f32_16x16x32_bf16 v[80:83], v[136:139], v[40:43], v[80:83]
v_mfma_f32_16x16x32_bf16 v[84:87], v[152:155], v[40:43], v[84:87]
v_mfma_f32_16x16x32_bf16 v[88:91], v[168:171], v[40:43], v[88:91]
v_mfma_f32_16x16x32_bf16 v[92:95], v[184:187], v[40:43], v[92:95]
s_waitcnt lgkmcnt(4)
v_mfma_f32_16x16x32_bf16 v[80:83], v[140:143], v[44:47], v[80:83]
v_mfma_f32_16x16x32_bf16 v[84:87], v[156:159], v[44:47], v[84:87]
v_mfma_f32_16x16x32_bf16 v[88:91], v[172:175], v[44:47], v[88:91]
v_mfma_f32_16x16x32_bf16 v[92:95], v[188:191], v[44:47], v[92:95]
v_mov_b64 v[100:101], 0
v_mov_b64 v[102:103], 0
v_mov_b64 v[104:105], 0
v_mov_b64 v[106:107], 0
v_mov_b32 v114, 0
v_mov_b32 v115, 1.0
v_add_f32_dpp v64, v81, v80 quad_perm:[1,0,3,2] row_mask:0xf bank_mask:0xf
v_add_f32_dpp v65, v85, v84 quad_perm:[1,0,3,2] row_mask:0xf bank_mask:0xf
v_add_f32_dpp v66, v83, v82 quad_perm:[1,0,3,2] row_mask:0xf bank_mask:0xf
v_add_f32_dpp v67, v87, v86 quad_perm:[1,0,3,2] row_mask:0xf bank_mask:0xf
v_add_f32_dpp v68, v89, v88 quad_perm:[1,0,3,2] row_mask:0xf bank_mask:0xf
v_add_f32_dpp v69, v93, v92 quad_perm:[1,0,3,2] row_mask:0xf bank_mask:0xf
v_add_f32_dpp v70, v91, v90 quad_perm:[1,0,3,2] row_mask:0xf bank_mask:0xf
v_add_f32_dpp v71, v95, v94 quad_perm:[1,0,3,2] row_mask:0xf bank_mask:0xf
v_max3_f32 v112, v64, v65, v66
v_max3_f32 v116, v67, v68, v69
v_max3_f32 v112, v112, v70, v71
v_max_f32 v112, v112, v116
v_mov_b32 v116, v112
s_nop 1
v_permlane16_swap_b32 v116, v112
v_max_f32 v112, v112, v116
v_mov_b32 v116, v112
s_nop 1
v_permlane32_swap_b32 v116, v112
v_max_f32 v112, v112, v116
v_mul_f32 v112, v112, v127
v_pk_fma_f32 v[64:65], v[64:65], v[126:127], v[112:113] op_sel:[0,1,0] op_sel_hi:[1,1,0] neg_lo:[0,0,1] neg_hi:[0,0,1]
v_pk_fma_f32 v[66:67], v[66:67], v[126:127], v[112:113] op_sel:[0,1,0] op_sel_hi:[1,1,0] neg_lo:[0,0,1] neg_hi:[0,0,1]
v_pk_fma_f32 v[68:69], v[68:69], v[126:127], v[112:113] op_sel:[0,1,0] op_sel_hi:[1,1,0] neg_lo:[0,0,1] neg_hi:[0,0,1]
v_pk_fma_f32 v[70:71], v[70:71], v[126:127], v[112:113] op_sel:[0,1,0] op_sel_hi:[1,1,0] neg_lo:[0,0,1] neg_hi:[0,0,1]
v_exp_f32_dpp v64, v64 quad_perm:[0,0,2,2] row_mask:0xf bank_mask:0xf
v_exp_f32_dpp v65, v65 quad_perm:[0,0,2,2] row_mask:0xf bank_mask:0xf
v_exp_f32_dpp v66, v66 quad_perm:[0,0,2,2] row_mask:0xf bank_mask:0xf
v_exp_f32_dpp v67, v67 quad_perm:[0,0,2,2] row_mask:0xf bank_mask:0xf
v_exp_f32_dpp v68, v68 quad_perm:[0,0,2,2] row_mask:0xf bank_mask:0xf
v_exp_f32_dpp v69, v69 quad_perm:[0,0,2,2] row_mask:0xf bank_mask:0xf
v_exp_f32_dpp v70, v70 quad_perm:[0,0,2,2] row_mask:0xf bank_mask:0xf
v_exp_f32_dpp v71, v71 quad_perm:[0,0,2,2] row_mask:0xf bank_mask:0xf
v_mov_b64 v[92:93], 0
v_mov_b64 v[94:95], 0
v_mov_b64 v[96:97], 0
v_mov_b64 v[98:99], 0
v_pk_add_f32 v[118:119], v[64:65], v[66:67]
v_pk_add_f32 v[118:119], v[118:119], v[68:69]
v_pk_add_f32 v[118:119], v[118:119], v[70:71]
v_add_f32 v113, v118, v119
v_mov_b32 v116, v113
s_nop 1
v_permlane16_swap_b32 v116, v113
v_add_f32 v113, v113, v116
v_mov_b32 v116, v113
s_nop 1
v_permlane32_swap_b32 v116, v113
v_add_f32 v113, v113, v116
v_cvt_pk_bf16_f32 v118, v64, v65
v_and_b32 v80, v118, v122
v_and_b32 v81, v118, v123
v_and_b32 v82, v118, v124
v_and_b32 v83, v118, v125
s_nop 1
v_smfmac_f32_16x16x64_bf16 v[92:95], v[80:83], v[192:199], v126
v_smfmac_f32_16x16x64_bf16 v[96:99], v[80:83], v[200:207], v126
v_cvt_pk_bf16_f32 v118, v66, v67
v_and_b32 v84, v118, v122
v_and_b32 v85, v118, v123
v_and_b32 v86, v118, v124
v_and_b32 v87, v118, v125
s_nop 1
v_smfmac_f32_16x16x64_bf16 v[92:95], v[84:87], v[208:215], v126
v_smfmac_f32_16x16x64_bf16 v[96:99], v[84:87], v[216:223], v126
v_cvt_pk_bf16_f32 v118, v68, v69
v_and_b32 v80, v118, v122
v_and_b32 v81, v118, v123
v_and_b32 v82, v118, v124
v_and_b32 v83, v118, v125
s_nop 1
v_smfmac_f32_16x16x64_bf16 v[92:95], v[80:83], v[224:231], v126
v_smfmac_f32_16x16x64_bf16 v[96:99], v[80:83], v[232:239], v126
v_cvt_pk_bf16_f32 v118, v70, v71
v_and_b32 v84, v118, v122
v_and_b32 v85, v118, v123
v_and_b32 v86, v118, v124
v_and_b32 v87, v118, v125
s_nop 1
v_smfmac_f32_16x16x64_bf16 v[92:95], v[84:87], v[240:247], v126
v_smfmac_f32_16x16x64_bf16 v[96:99], v[84:87], v[248:255], v126
s_nop 7
s_branch L_att_1
L_gs5:
buffer_store_dwordx2 v[64:65], v3, s[52:55], s84 offen sc1
s_mov_b64 exec, 1
buffer_store_dword v59, v6, s[52:55], s85 offen sc1
s_mov_b64 exec, -1
s_branch L_gsb5
L_g1r_1:
s_cmp_lg_u32 s89, 0
s_cbranch_scc1 L_g1ok_1
s_mov_b32 s88, 0
L_g1rl_1:
buffer_load_dwordx4 v[32:35], v4, s[52:55], s81 offen offset:0 sc1
buffer_load_dwordx4 v[36:39], v4, s[52:55], s81 offen offset:1024 sc1
buffer_load_dwordx4 v[40:43], v4, s[52:55], s81 offen offset:2048 sc1
buffer_load_dwordx4 v[44:47], v4, s[52:55], s81 offen offset:3072 sc1
buffer_load_dwordx4 v[48:51], v4, s[52:55], s82 offen offset:0 sc1
buffer_load_dwordx4 v[52:55], v4, s[52:55], s82 offen offset:1024 sc1
buffer_load_dwordx4 v[56:59], v4, s[52:55], s82 offen offset:2048 sc1
buffer_load_dwordx4 v[60:63], v4, s[52:55], s82 offen offset:3072 sc1
buffer_load_dwordx4 v[64:67], v5, s[52:55], s79 offen sc1
buffer_load_dwordx4 v[68:71], v5, s[52:55], s79 offen offset:16 sc1
s_waitcnt vmcnt(0)
v_max3_u32 v79, v32, v33, v34
v_max3_u32 v79, v79, v35, v36
v_max3_u32 v79, v79, v37, v38
v_max3_u32 v79, v79, v39, v40
v_max3_u32 v79, v79, v41, v42
v_max3_u32 v79, v79, v43, v44
v_max3_u32 v79, v79, v45, v46
v_max3_u32 v79, v79, v47, v48
v_max3_u32 v79, v79, v49, v50
v_max3_u32 v79, v79, v51, v52
v_max3_u32 v79, v79, v53, v54
v_max3_u32 v79, v79, v55, v56
v_max3_u32 v79, v79, v57, v58
v_max3_u32 v79, v79, v59, v60
v_max3_u32 v79, v79, v61, v62
v_max3_u32 v79, v79, v63, v64
v_max3_u32 v79, v79, v65, v66
v_max3_u32 v79, v79, v67, v68
v_max3_u32 v79, v79, v69, v70
v_max_u32 v79, v79, v71
v_cmp_eq_u32 vcc, -1, v79
s_mov_b32 s89, 1
s_cbranch_vccz L_g1c_1
s_add_u32 s88, s88, 1
s_cmp_lt_u32 s88, 200000
s_cbranch_scc1 L_g1rl_1
s_branch L_g1c_1
L_g2r_1:
s_cmp_lg_u32 s89, 0
s_cbranch_scc1 L_g2ok_1
s_mov_b32 s88, 0
L_g2rl_1:
v_subrev_u32 v92, 98304, v23
v_subrev_u32 v93, 98304, v24
buffer_load_dwordx4 v[32:35], v8, s[52:55], s80 offen offset:0 sc1
buffer_load_dwordx4 v[36:39], v8, s[52:55], s80 offen offset:1024 sc1
buffer_load_dwordx4 v[40:43], v8, s[52:55], s80 offen offset:2048 sc1
buffer_load_dwordx4 v[44:47], v8, s[52:55], s80 offen offset:3072 sc1
buffer_load_dwordx4 v[48:51], v9, s[52:55], s80 offen offset:0 sc1
buffer_load_dwordx4 v[52:55], v9, s[52:55], s80 offen offset:1024 sc1
buffer_load_dwordx4 v[56:59], v9, s[52:55], s80 offen offset:2048 sc1
buffer_load_dwordx4 v[60:63], v9, s[52:55], s80 offen offset:3072 sc1
buffer_load_dwordx2 v[84:85], v92, s[60:63], s24 offen sc1
buffer_load_dwordx2 v[88:89], v93, s[60:63], s24 offen sc1
s_waitcnt vmcnt(0)
v_max3_u32 v79, v32, v33, v34
v_max3_u32 v79, v79, v35, v36
v_max3_u32 v79, v79, v37, v38
v_max3_u32 v79, v79, v39, v40
v_max3_u32 v79, v79, v41, v42
v_max3_u32 v79, v79, v43, v44
v_max3_u32 v79, v79, v45, v46
v_max3_u32 v79, v79, v47, v48
v_max3_u32 v79, v79, v49, v50
v_max3_u32 v79, v79, v51, v52
v_max3_u32 v79, v79, v53, v54
v_max3_u32 v79, v79, v55, v56
v_max3_u32 v79, v79, v57, v58
v_max3_u32 v79, v79, v59, v60
v_max3_u32 v79, v79, v61, v62
v_max3_u32 v79, v79, v63, v84
v_max3_u32 v79, v79, v85, v88
v_max_u32 v79, v79, v89
v_cmp_eq_u32 vcc, -1, v79
s_mov_b32 s89, 1
s_cbranch_vccz L_g2c_1
s_add_u32 s88, s88, 1
s_cmp_lt_u32 s88, 200000
s_cbranch_scc1 L_g2rl_1
s_branch L_g2c_1
L_gs6:
buffer_store_dwordx2 v[36:37], v10, s[52:55], s76 offen sc1
buffer_store_dwordx2 v[40:41], v10, s[52:55], s42 offen sc1
s_branch L_gsb6
L_gs7:
buffer_store_dwordx2 v[120:121], v3, s[52:55], s83 offen sc1
s_mov_b64 exec, 1
buffer_store_dword v120, v6, s[52:55], s43 offen sc1
s_mov_b64 exec, -1
s_branch L_gsb7
L_oo_2:
s_waitcnt lgkmcnt(7)
v_mfma_f32_16x16x32_bf16 v[80:83], a[0:3], v[32:35], 0
v_mfma_f32_16x16x32_bf16 v[84:87], a[16:19], v[32:35], 0
v_mfma_f32_16x16x32_bf16 v[88:91], a[32:35], v[32:35], 0
v_mfma_f32_16x16x32_bf16 v[92:95], a[48:51], v[32:35], 0
s_waitcnt lgkmcnt(6)
v_mfma_f32_16x16x32_bf16 v[80:83], a[4:7], v[36:39], v[80:83]
v_mfma_f32_16x16x32_bf16 v[84:87], a[20:23], v[36:39], v[84:87]
v_mfma_f32_16x16x32_bf16 v[88:91], a[36:39], v[36:39], v[88:91]
v_mfma_f32_16x16x32_bf16 v[92:95], a[52:55], v[36:39], v[92:95]
s_waitcnt lgkmcnt(5)
v_mfma_f32_16x16x32_bf16 v[80:83], a[8:11], v[40:43], v[80:83]
v_mfma_f32_16x16x32_bf16 v[84:87], a[24:27], v[40:43], v[84:87]
v_mfma_f32_16x16x32_bf16 v[88:91], a[40:43], v[40:43], v[88:91]
v_mfma_f32_16x16x32_bf16 v[92:95], a[56:59], v[40:43], v[92:95]
s_waitcnt lgkmcnt(4)
v_mfma_f32_16x16x32_bf16 v[80:83], a[12:15], v[44:47], v[80:83]
v_mfma_f32_16x16x32_bf16 v[84:87], a[28:31], v[44:47], v[84:87]
v_mfma_f32_16x16x32_bf16 v[88:91], a[44:47], v[44:47], v[88:91]
v_mfma_f32_16x16x32_bf16 v[92:95], a[60:63], v[44:47], v[92:95]
v_mov_b64 v[100:101], 0
v_mov_b64 v[102:103], 0
v_mov_b64 v[104:105], 0
v_mov_b64 v[106:107], 0
v_mov_b32 v114, 0
v_mov_b32 v115, 1.0
v_add_f32_dpp v64, v81, v80 quad_perm:[1,0,3,2] row_mask:0xf bank_mask:0xf
v_add_f32_dpp v65, v85, v84 quad_perm:[1,0,3,2] row_mask:0xf bank_mask:0xf
v_add_f32_dpp v66, v83, v82 quad_perm:[1,0,3,2] row_mask:0xf bank_mask:0xf
v_add_f32_dpp v67, v87, v86 quad_perm:[1,0,3,2] row_mask:0xf bank_mask:0xf
v_add_f32_dpp v68, v89, v88 quad_perm:[1,0,3,2] row_mask:0xf bank_mask:0xf
v_add_f32_dpp v69, v93, v92 quad_perm:[1,0,3,2] row_mask:0xf bank_mask:0xf
v_add_f32_dpp v70, v91, v90 quad_perm:[1,0,3,2] row_mask:0xf bank_mask:0xf
v_add_f32_dpp v71, v95, v94 quad_perm:[1,0,3,2] row_mask:0xf bank_mask:0xf
v_max3_f32 v112, v64, v65, v66
v_max3_f32 v116, v67, v68, v69
v_max3_f32 v112, v112, v70, v71
v_max_f32 v112, v112, v116
v_mov_b32 v116, v112
s_nop 1
v_permlane16_swap_b32 v116, v112
v_max_f32 v112, v112, v116
v_mov_b32 v116, v112
s_nop 1
v_permlane32_swap_b32 v116, v112
v_max_f32 v112, v112, v116
v_mul_f32 v112, v112, v127
v_pk_fma_f32 v[64:65], v[64:65], v[126:127], v[112:113] op_sel:[0,1,0] op_sel_hi:[1,1,0] neg_lo:[0,0,1] neg_hi:[0,0,1]
v_pk_fma_f32 v[66:67], v[66:67], v[126:127], v[112:113] op_sel:[0,1,0] op_sel_hi:[1,1,0] neg_lo:[0,0,1] neg_hi:[0,0,1]
v_pk_fma_f32 v[68:69], v[68:69], v[126:127], v[112:113] op_sel:[0,1,0] op_sel_hi:[1,1,0] neg_lo:[0,0,1] neg_hi:[0,0,1]
v_pk_fma_f32 v[70:71], v[70:71], v[126:127], v[112:113] op_sel:[0,1,0] op_sel_hi:[1,1,0] neg_lo:[0,0,1] neg_hi:[0,0,1]
v_exp_f32_dpp v64, v64 quad_perm:[0,0,2,2] row_mask:0xf bank_mask:0xf
v_exp_f32_dpp v65, v65 quad_perm:[0,0,2,2] row_mask:0xf bank_mask:0xf
v_exp_f32_dpp v66, v66 quad_perm:[0,0,2,2] row_mask:0xf bank_mask:0xf
v_exp_f32_dpp v67, v67 quad_perm:[0,0,2,2] row_mask:0xf bank_mask:0xf
v_exp_f32_dpp v68, v68 quad_perm:[0,0,2,2] row_mask:0xf bank_mask:0xf
v_exp_f32_dpp v69, v69 quad_perm:[0,0,2,2] row_mask:0xf bank_mask:0xf
v_exp_f32_dpp v70, v70 quad_perm:[0,0,2,2] row_mask:0xf bank_mask:0xf
v_exp_f32_dpp v71, v71 quad_perm:[0,0,2,2] row_mask:0xf bank_mask:0xf
v_mov_b64 v[92:93], 0
v_mov_b64 v[94:95], 0
v_mov_b64 v[96:97], 0
v_mov_b64 v[98:99], 0
v_pk_add_f32 v[118:119], v[64:65], v[66:67]
v_pk_add_f32 v[118:119], v[118:119], v[68:69]
v_pk_add_f32 v[118:119], v[118:119], v[70:71]
v_add_f32 v113, v118, v119
v_mov_b32 v116, v113
s_nop 1
v_permlane16_swap_b32 v116, v113
v_add_f32 v113, v113, v116
v_mov_b32 v116, v113
s_nop 1
v_permlane32_swap_b32 v116, v113
v_add_f32 v113, v113, v116
v_cvt_pk_bf16_f32 v118, v64, v65
v_and_b32 v80, v118, v122
v_and_b32 v81, v118, v123
v_and_b32 v82, v118, v124
v_and_b32 v83, v118, v125
s_nop 1
v_smfmac_f32_16x16x64_bf16 v[92:95], v[80:83], a[64:71], v126
v_smfmac_f32_16x16x64_bf16 v[96:99], v[80:83], a[72:79], v126
v_cvt_pk_bf16_f32 v118, v66, v67
v_and_b32 v84, v118, v122
v_and_b32 v85, v118, v123
v_and_b32 v86, v118, v124
v_and_b32 v87, v118, v125
s_nop 1
v_smfmac_f32_16x16x64_bf16 v[92:95], v[84:87], a[80:87], v126
v_smfmac_f32_16x16x64_bf16 v[96:99], v[84:87], a[88:95], v126
v_cvt_pk_bf16_f32 v118, v68, v69
v_and_b32 v80, v118, v122
v_and_b32 v81, v118, v123
v_and_b32 v82, v118, v124
v_and_b32 v83, v118, v125
s_nop 1
v_smfmac_f32_16x16x64_bf16 v[92:95], v[80:83], a[96:103], v126
v_smfmac_f32_16x16x64_bf16 v[96:99], v[80:83], a[104:111], v126
v_cvt_pk_bf16_f32 v118, v70, v71
v_and_b32 v84, v118, v122
v_and_b32 v85, v118, v123
v_and_b32 v86, v118, v124
v_and_b32 v87, v118, v125
s_nop 1
v_smfmac_f32_16x16x64_bf16 v[92:95], v[84:87], a[112:119], v126
v_smfmac_f32_16x16x64_bf16 v[96:99], v[84:87], a[120:127], v126
s_nop 7
s_branch L_att_2
L_gs8:
buffer_store_dwordx2 v[64:65], v3, s[52:55], s84 offen sc1
s_mov_b64 exec, 1
buffer_store_dword v59, v6, s[52:55], s85 offen sc1
s_mov_b64 exec, -1
s_branch L_gsb8
L_g1r_2:
s_cmp_lg_u32 s89, 0
s_cbranch_scc1 L_g1ok_2
s_mov_b32 s88, 0
L_g1rl_2:
buffer_load_dwordx4 v[32:35], v4, s[52:55], s81 offen offset:0 sc1
buffer_load_dwordx4 v[36:39], v4, s[52:55], s81 offen offset:1024 sc1
buffer_load_dwordx4 v[40:43], v4, s[52:55], s81 offen offset:2048 sc1
buffer_load_dwordx4 v[44:47], v4, s[52:55], s81 offen offset:3072 sc1
buffer_load_dwordx4 v[48:51], v4, s[52:55], s82 offen offset:0 sc1
buffer_load_dwordx4 v[52:55], v4, s[52:55], s82 offen offset:1024 sc1
buffer_load_dwordx4 v[56:59], v4, s[52:55], s82 offen offset:2048 sc1
buffer_load_dwordx4 v[60:63], v4, s[52:55], s82 offen offset:3072 sc1
buffer_load_dwordx4 v[64:67], v5, s[52:55], s79 offen sc1
buffer_load_dwordx4 v[68:71], v5, s[52:55], s79 offen offset:16 sc1
s_waitcnt vmcnt(0)
v_max3_u32 v79, v32, v33, v34
v_max3_u32 v79, v79, v35, v36
v_max3_u32 v79, v79, v37, v38
v_max3_u32 v79, v79, v39, v40
v_max3_u32 v79, v79, v41, v42
v_max3_u32 v79, v79, v43, v44
v_max3_u32 v79, v79, v45, v46
v_max3_u32 v79, v79, v47, v48
v_max3_u32 v79, v79, v49, v50
v_max3_u32 v79, v79, v51, v52
v_max3_u32 v79, v79, v53, v54
v_max3_u32 v79, v79, v55, v56
v_max3_u32 v79, v79, v57, v58
v_max3_u32 v79, v79, v59, v60
v_max3_u32 v79, v79, v61, v62
v_max3_u32 v79, v79, v63, v64
v_max3_u32 v79, v79, v65, v66
v_max3_u32 v79, v79, v67, v68
v_max3_u32 v79, v79, v69, v70
v_max_u32 v79, v79, v71
v_cmp_eq_u32 vcc, -1, v79
s_mov_b32 s89, 1
s_cbranch_vccz L_g1c_2
s_add_u32 s88, s88, 1
s_cmp_lt_u32 s88, 200000
s_cbranch_scc1 L_g1rl_2
s_branch L_g1c_2
L_g2r_2:
s_cmp_lg_u32 s89, 0
s_cbranch_scc1 L_g2ok_2
s_mov_b32 s88, 0
L_g2rl_2:
v_subrev_u32 v92, 98304, v23
v_subrev_u32 v93, 98304, v24
buffer_load_dwordx4 v[32:35], v8, s[52:55], s80 offen offset:0 sc1
buffer_load_dwordx4 v[36:39], v8, s[52:55], s80 offen offset:1024 sc1
buffer_load_dwordx4 v[40:43], v8, s[52:55], s80 offen offset:2048 sc1
buffer_load_dwordx4 v[44:47], v8, s[52:55], s80 offen offset:3072 sc1
buffer_load_dwordx4 v[48:51], v9, s[52:55], s80 offen offset:0 sc1
buffer_load_dwordx4 v[52:55], v9, s[52:55], s80 offen offset:1024 sc1
buffer_load_dwordx4 v[56:59], v9, s[52:55], s80 offen offset:2048 sc1
buffer_load_dwordx4 v[60:63], v9, s[52:55], s80 offen offset:3072 sc1
buffer_load_dwordx2 v[84:85], v92, s[60:63], s24 offen sc1
buffer_load_dwordx2 v[88:89], v93, s[60:63], s24 offen sc1
s_waitcnt vmcnt(0)
v_max3_u32 v79, v32, v33, v34
v_max3_u32 v79, v79, v35, v36
v_max3_u32 v79, v79, v37, v38
v_max3_u32 v79, v79, v39, v40
v_max3_u32 v79, v79, v41, v42
v_max3_u32 v79, v79, v43, v44
v_max3_u32 v79, v79, v45, v46
v_max3_u32 v79, v79, v47, v48
v_max3_u32 v79, v79, v49, v50
v_max3_u32 v79, v79, v51, v52
v_max3_u32 v79, v79, v53, v54
v_max3_u32 v79, v79, v55, v56
v_max3_u32 v79, v79, v57, v58
v_max3_u32 v79, v79, v59, v60
v_max3_u32 v79, v79, v61, v62
v_max3_u32 v79, v79, v63, v84
v_max3_u32 v79, v79, v85, v88
v_max_u32 v79, v79, v89
v_cmp_eq_u32 vcc, -1, v79
s_mov_b32 s89, 1
s_cbranch_vccz L_g2c_2
s_add_u32 s88, s88, 1
s_cmp_lt_u32 s88, 200000
s_cbranch_scc1 L_g2rl_2
s_branch L_g2c_2
L_gs9:
buffer_store_dwordx2 v[36:37], v10, s[52:55], s76 offen sc1
buffer_store_dwordx2 v[40:41], v10, s[52:55], s42 offen sc1
s_branch L_gsb9
.section .rodata,"a"
.p2align 6
.amdhsa_kernel interleave_layers__gqa_block_cached__gqa_block_cached__decode_kernel
  .amdhsa_next_free_vgpr 512
  .amdhsa_next_free_sgpr 102
  .amdhsa_accum_offset 256
  .amdhsa_group_segment_fixed_size 0
  .amdhsa_kernarg_size 104
  .amdhsa_user_sgpr_count 2
  .amdhsa_user_sgpr_kernarg_segment_ptr 1
  .amdhsa_system_sgpr_workgroup_id_x 1
.end_amdhsa_kernel
```
